```python
import torch

def _softmax(x, axis=-1):
    return torch.softmax(x, dim=axis)

def _gelu(x):
    return torch.nn.functional.gelu(x, approximate='tanh')

def _silu(x):
    return torch.nn.functional.silu(x)

def _sigmoid(x):
    return torch.sigmoid(x)

def _layernorm(x, axis=-1, eps=1e-05):
    m = x.mean(dim=axis, keepdim=True)
    v = x.var(dim=axis, keepdim=True, unbiased=False)
    return (x - m) / torch.sqrt(v + eps)

def _scatter_add(tgt, idx, src, axis=0):
    return tgt.clone().index_add_(axis, idx, src)

def _segment_sum(src, seg, n):
    out = torch.zeros((n,) + src.shape[1:], dtype=src.dtype)
    return out.index_add_(0, seg, src)

def _pad(x, pw):
    flat = tuple((v for pair in reversed(pw) for v in pair))
    return torch.nn.functional.pad(x, flat)
kernel_name = 'adaLN_cond__compressed_kv_cla__dense_activation_squared_relu__decode'

def setup_inputs():

    _w = lambda a: (lambda t: t.to(torch.bfloat16) if t.is_floating_point() else t)(torch.as_tensor(a))

    def _A_setup():
        B, H, Sq, Sk, D, M = (2, 32, 1, 4096, 128, 640)
        Dc = 4 * D
        return {'x': _w((lambda *s: torch.randn(*s, dtype=torch.bfloat16) * 0.05)(B, Sq, M)), 'c_kv': _w((lambda *s: torch.randn(*s, dtype=torch.bfloat16) * 1.6)(B, Sk, Dc)), 'w_q': _w((lambda *s: torch.randn(*s, dtype=torch.bfloat16) * 0.8)(M, H, D) * M ** (-0.5)), 'w_uk': _w((lambda *s: torch.randn(*s, dtype=torch.bfloat16) * 0.8)(Dc, H, D) * Dc ** (-0.5)), 'w_uv': _w((lambda *s: torch.randn(*s, dtype=torch.bfloat16) * 1.6)(Dc, H, D) * Dc ** (-0.5)), 'w_o': _w((lambda *s: torch.randn(*s, dtype=torch.bfloat16) * 1.6)(H, D, M) * (H * D) ** (-0.5))}
    _A_in = _A_setup()

    def _B_setup():
        B, S, D, F = (2, 1, 640, 1728)
        return {'x': _w((lambda *s: torch.randn(*s, dtype=torch.bfloat16) * 0.05)(B, S, D)), 'w1': _w((lambda *s: torch.randn(*s, dtype=torch.bfloat16) * 0.05)(D, F)), 'b1': _w((lambda *s: torch.randn(*s, dtype=torch.bfloat16) * 0.2)(F)), 'w2': _w((lambda *s: torch.randn(*s, dtype=torch.bfloat16) * 0.05)(F, D)), 'b2': _w((lambda *s: torch.randn(*s, dtype=torch.bfloat16) * 1.6)(D))}
    _B_in = _B_setup()
    return {'A_x': _A_in['x'], 'A_c_kv': _A_in['c_kv'], 'A_w_q': _A_in['w_q'], 'A_w_uk': _A_in['w_uk'], 'A_w_uv': _A_in['w_uv'], 'A_w_o': _A_in['w_o'], 'B_x': _B_in['x'], 'B_w1': _B_in['w1'], 'B_b1': _B_in['b1'], 'B_w2': _B_in['w2'], 'B_b2': _B_in['b2'], 'c': _w((lambda *s: torch.randn(*s, dtype=torch.bfloat16) * 0.1)(2, 640) * 8.0), 'w_mod': _w((lambda *s: torch.randn(*s, dtype=torch.bfloat16) * 0.1)(640, 6 * 640) * 640 ** (-0.5) * 8.0)}

def reference(A_x, A_c_kv, A_w_q, A_w_uk, A_w_uv, A_w_o, B_x, B_w1, B_b1, B_w2, B_b2, c, w_mod):

    def _A_ref(x, c_kv, w_q, w_uk, w_uv, w_o):
        B, Sq, M = (x.shape[0], x.shape[1], x.shape[2])
        Sk = c_kv.shape[1]
        H, D = (w_q.shape[1], w_q.shape[2])
        q = torch.einsum('bqm,mhd->bhqd', x, w_q)
        k = torch.einsum('bkc,chd->bhkd', c_kv, w_uk)
        v = torch.einsum('bkc,chd->bhkd', c_kv, w_uv)
        scores = torch.einsum('bhqd,bhkd->bhqk', q, k) * D ** (-0.5)
        off = Sk - Sq
        qi = torch.arange(Sq)[:, None]
        kj = torch.arange(Sk)[None, :]
        cmask = kj <= qi + off
        scores = torch.where(cmask[None, None], scores, -1000000000.0)
        p = _softmax(scores, axis=-1)
        ctx = torch.einsum('bhqk,bhkd->bhqd', p, v)
        return torch.einsum('bhqd,hdm->bqm', ctx, w_o)

    def _B_ref(x, w1, b1, w2, b2):
        h = torch.einsum('bsd,df->bsf', x, w1) + b1
        zero = torch.zeros_like(h)
        r = torch.where(h > zero, h, zero)
        h = r * r
        out = torch.einsum('bsf,fd->bsd', h, w2) + b2
        return out
    x = A_x
    mod = (_silu(c) @ w_mod).reshape(c.shape[0], 6, 1, -1)
    sa, ca, ga, sb, cb, gb = (mod[:, 0].clone(), mod[:, 1].clone(), mod[:, 2].clone(), mod[:, 3].clone(), mod[:, 4].clone(), mod[:, 5].clone())
    h = _layernorm(x, axis=-1) * (1 + ca) + sa
    x = x + ga * _A_ref(h, A_c_kv, A_w_q, A_w_uk, A_w_uv, A_w_o)
    h = _layernorm(x, axis=-1) * (1 + cb) + sb
    x = x + gb * _B_ref(h, B_w1, B_b1, B_w2, B_b2)
    return x
```

```asm
; @launch grid=(256,1,1) block=(512,1,1) lds=163840
.amdgcn_target "amdgcn-amd-amdhsa--gfx950"
.text
.globl adaLN_cond__compressed_kv_cla__dense_activation_squared_relu__decode_kernel
.p2align 8
.type adaLN_cond__compressed_kv_cla__dense_activation_squared_relu__decode_kernel,@function
adaLN_cond__compressed_kv_cla__dense_activation_squared_relu__decode_kernel:
    s_cmp_ge_u32 s2, 256
    s_cbranch_scc1 L_end
    s_load_dwordx2 s[16:17], s[0:1], 0
    s_load_dwordx2 s[20:21], s[0:1], 8
    s_load_dwordx2 s[24:25], s[0:1], 16
    s_load_dwordx2 s[28:29], s[0:1], 24
    s_load_dwordx2 s[32:33], s[0:1], 32
    s_load_dwordx2 s[36:37], s[0:1], 40
    s_load_dwordx2 s[40:41], s[0:1], 56
    s_load_dwordx2 s[44:45], s[0:1], 64
    s_load_dwordx2 s[48:49], s[0:1], 72
    s_load_dwordx2 s[52:53], s[0:1], 80
    s_load_dwordx2 s[56:57], s[0:1], 88
    s_load_dwordx2 s[60:61], s[0:1], 96
    s_load_dwordx2 s[64:65], s[0:1], 104
    s_load_dwordx2 s[68:69], s[0:1], 112
    s_load_dwordx2 s[72:73], s[0:1], 120
    v_lshrrev_b32 v1, 6, v0
    v_and_b32 v0, 63, v0
    v_readfirstlane_b32 s78, v1
    s_mov_b32 s18, 2560
    s_mov_b32 s19, 0x20000
    s_mov_b32 s22, 8388608
    s_mov_b32 s23, 0x20000
    s_mov_b32 s26, 5242880
    s_mov_b32 s27, 0x20000
    s_mov_b32 s30, 4194304
    s_mov_b32 s31, 0x20000
    s_mov_b32 s34, 4194304
    s_mov_b32 s35, 0x20000
    s_mov_b32 s38, 5242880
    s_mov_b32 s39, 0x20000
    s_mov_b32 s42, 2211840
    s_mov_b32 s43, 0x20000
    s_mov_b32 s46, 3456
    s_mov_b32 s47, 0x20000
    s_mov_b32 s50, 2211840
    s_mov_b32 s51, 0x20000
    s_mov_b32 s54, 1280
    s_mov_b32 s55, 0x20000
    s_mov_b32 s58, 2560
    s_mov_b32 s59, 0x20000
    s_mov_b32 s62, 4915200
    s_mov_b32 s63, 0x20000
    s_mov_b32 s66, 2560
    s_mov_b32 s67, 0x20000
    s_mov_b32 s70, 256
    s_mov_b32 s71, 0x20000
    s_mov_b32 s74, 4456448
    s_mov_b32 s75, 0x20000
    s_and_b32 s76, s2, 7
    s_lshr_b32 s77, s2, 3
    s_xor_b32 s77, s77, 16
    s_mov_b32 s87, 0
    v_and_b32 v1, 15, v0
    v_lshrrev_b32 v2, 4, v0
    s_and_b32 s79, s78, 3
    s_lshr_b32 s90, s78, 2
    s_sub_u32 s80, s77, 16
    v_mov_b32 v253, 0
    s_waitcnt lgkmcnt(0)
    buffer_load_dwordx2 v[254:255], v253, s[72:75], 0 offen offset:2048
    s_cmp_lt_u32 s77, 16
    s_cbranch_scc1 L_att
    s_lshr_b32 s81, s80, 1
    s_lshr_b32 s4, s76, 1
    s_lshl_b32 s4, s4, 3
    s_add_u32 s81, s81, s4
    s_and_b32 s91, s76, 1
    s_lshl_b32 s91, s91, 1
    s_and_b32 s4, s80, 1
    s_add_u32 s91, s91, s4
    v_and_b32 v12, 1, v1
    v_and_b32 v13, 7, v1
    s_cmp_eq_u32 s90, 1
    s_cbranch_scc1 L_g1
    s_cmp_lt_u32 s80, 10
    s_cselect_b32 s14, 1, 0
    v_lshrrev_b32 v8, 3, v0
    v_and_b32 v9, 7, v0
    v_lshlrev_b32 v9, 4, v9
    v_min_u32 v14, 39, v0
    v_bfe_u32 v10, v0, 2, 2
    v_lshl_add_u32 v10, v2, 3, v10
    v_and_b32 v15, 3, v0
    v_lshlrev_b32 v15, 3, v15
    v_lshl_add_u32 v11, v10, 8, v15
    v_lshl_add_u32 v10, v10, 7, v15
    s_lshl_b32 s4, s79, 5
    v_add_u32 v10, s4, v10
    s_lshl_b32 s4, s79, 6
    v_add_u32 v11, s4, v11
    s_cmp_eq_u32 s14, 0
    s_cbranch_scc1 L_f_nop0c_ld
    s_mul_i32 s83, s76, 10
    s_add_u32 s83, s83, s80
    s_lshr_b32 s94, s83, 2
    s_and_b32 s93, s83, 3
    v_cmp_le_u32 vcc, 20, v14
    v_mov_b32 v15, 0
    v_mov_b32 v102, 1
    s_nop 0
    v_cndmask_b32 v15, v15, v102, vcc
    v_mul_u32_u24 v102, 20, v15
    v_sub_u32 v102, v14, v102
    v_lshlrev_b32 v102, 4, v102
    s_mul_i32 s5, s93, 320
    v_mul_u32_u24 v100, 1280, v15
    v_add3_u32 v100, v100, v102, s5
    buffer_load_dwordx4 v[84:87], v100, s[56:59], 0 offen offset:0
    v_mul_u32_u24 v101, 336, v15
    v_add_u32 v101, v101, v102
    v_add_u32 v101, 61440, v101
    s_mul_i32 s5, s93, 160
    s_mul_i32 s6, s79, 40
    s_add_u32 s5, s5, s6
    v_add_u32 v100, s5, v8
    s_movk_i32 s7, 7680
    v_mul_lo_u32 v100, v100, s7
    s_lshl_b32 s5, s94, 7
    v_add3_u32 v100, v100, v9, s5
    s_mul_i32 s5, s79, 5120
    s_add_u32 s5, s5, 40960
    s_mov_b32 m0, s5
    s_nop 0
    buffer_load_dwordx4 v100, s[60:63], 0 offen nt lds
    s_add_u32 s5, s5, 1024
    s_mov_b32 m0, s5
    v_add_u32 v100, 61440, v100
    buffer_load_dwordx4 v100, s[60:63], 0 offen nt lds
    s_add_u32 s5, s5, 1024
    s_mov_b32 m0, s5
    v_add_u32 v100, 61440, v100
    buffer_load_dwordx4 v100, s[60:63], 0 offen nt lds
    s_add_u32 s5, s5, 1024
    s_mov_b32 m0, s5
    v_add_u32 v100, 61440, v100
    buffer_load_dwordx4 v100, s[60:63], 0 offen nt lds
    s_add_u32 s5, s5, 1024
    s_mov_b32 m0, s5
    v_add_u32 v100, 61440, v100
    buffer_load_dwordx4 v100, s[60:63], 0 offen nt lds
L_f_nop0c_ld:
    v_lshrrev_b32 v100, 5, v0
    v_mul_u32_u24 v100, 1280, v100
    v_and_b32 v102, 31, v0
    v_lshl_add_u32 v100, v102, 3, v100
    buffer_load_dwordx2 v[88:89], v100, s[16:19], 0 offen offset:0
    buffer_load_dwordx2 v[90:91], v100, s[16:19], 0 offen offset:256
    buffer_load_dwordx2 v[92:93], v100, s[16:19], 0 offen offset:512
    buffer_load_dwordx2 v[94:95], v100, s[16:19], 0 offen offset:768
    buffer_load_dwordx2 v[96:97], v100, s[16:19], 0 offen offset:1024
    s_mul_i32 s5, s91, 320
    v_lshlrev_b32 v100, 3, v14
    v_add_u32 v100, s5, v100
    buffer_load_dwordx2 v[104:105], v100, s[16:19], 0 offen offset:0
    buffer_load_dwordx2 v[106:107], v100, s[16:19], 0 offen offset:1280
    s_cmp_lg_u32 s78, 0
    s_cbranch_scc1 L_f_noinit
    v_lshlrev_b32 v100, 2, v1
    v_add_u32 v100, 158976, v100
    v_mov_b32 v102, 0
    ds_write_b32 v100, v102
    s_waitcnt lgkmcnt(0)
L_f_noinit:
    s_barrier
    s_cmp_eq_u32 s14, 0
    s_cbranch_scc1 L_f_nop0c
    s_waitcnt vmcnt(12)
    v_lshlrev_b32 v110, 16, v84
    v_and_b32 v111, 0xffff0000, v84
    v_lshlrev_b32 v112, 16, v85
    v_and_b32 v113, 0xffff0000, v85
    v_lshlrev_b32 v114, 16, v86
    v_and_b32 v115, 0xffff0000, v86
    v_lshlrev_b32 v116, 16, v87
    v_and_b32 v117, 0xffff0000, v87
    v_mul_f32 v118, 0xbfb8aa3b, v110
    v_mul_f32 v119, 0xbfb8aa3b, v111
    v_mul_f32 v120, 0xbfb8aa3b, v112
    v_mul_f32 v121, 0xbfb8aa3b, v113
    v_mul_f32 v122, 0xbfb8aa3b, v114
    v_mul_f32 v123, 0xbfb8aa3b, v115
    v_mul_f32 v124, 0xbfb8aa3b, v116
    v_mul_f32 v125, 0xbfb8aa3b, v117
    v_exp_f32 v118, v118
    v_exp_f32 v119, v119
    v_exp_f32 v120, v120
    v_exp_f32 v121, v121
    v_exp_f32 v122, v122
    v_exp_f32 v123, v123
    v_exp_f32 v124, v124
    v_exp_f32 v125, v125
    s_nop 0
    v_add_f32 v118, 1.0, v118
    v_add_f32 v119, 1.0, v119
    v_add_f32 v120, 1.0, v120
    v_add_f32 v121, 1.0, v121
    v_add_f32 v122, 1.0, v122
    v_add_f32 v123, 1.0, v123
    v_add_f32 v124, 1.0, v124
    v_add_f32 v125, 1.0, v125
    v_rcp_f32 v118, v118
    v_rcp_f32 v119, v119
    v_rcp_f32 v120, v120
    v_rcp_f32 v121, v121
    v_rcp_f32 v122, v122
    v_rcp_f32 v123, v123
    v_rcp_f32 v124, v124
    v_rcp_f32 v125, v125
    s_nop 0
    v_mul_f32 v110, v110, v118
    v_mul_f32 v111, v111, v119
    v_mul_f32 v112, v112, v120
    v_mul_f32 v113, v113, v121
    v_mul_f32 v114, v114, v122
    v_mul_f32 v115, v115, v123
    v_mul_f32 v116, v116, v124
    v_mul_f32 v117, v117, v125
    v_cvt_pk_bf16_f32 v84, v110, v111
    v_cvt_pk_bf16_f32 v85, v112, v113
    v_cvt_pk_bf16_f32 v86, v114, v115
    v_cvt_pk_bf16_f32 v87, v116, v117
    ds_write_b128 v101, v[84:87]
    v_mul_u32_u24 v108, 336, v12
    v_lshl_add_u32 v108, v2, 4, v108
    v_add_u32 v108, 61440, v108
    ds_read_b128 v[110:113], v108 offset:0
    ds_read_b128 v[114:117], v108 offset:64
    ds_read_b128 v[118:121], v108 offset:128
    ds_read_b128 v[122:125], v108 offset:192
    ds_read_b128 v[126:129], v108 offset:256
    s_waitcnt vmcnt(7)
    s_mov_b64 exec, 1
    v_mov_b32 v100, 159008
    v_mov_b32 v102, 1
    ds_add_u32 v100, v102
L_gs_1:
    ds_read_b32 v102, v100
    s_waitcnt lgkmcnt(0)
    v_readfirstlane_b32 s4, v102
    s_nop 2
    s_cmp_ge_u32 s4, 4
    s_cbranch_scc1 L_gs_done_2
    s_add_u32 s87, s87, 1
    s_cmp_lt_u32 s87, 400000
    s_cbranch_scc1 L_gs_1
    s_branch L_bail
L_gs_done_2:
    s_mov_b64 exec, -1
    v_add_u32 v100, 40960, v10
    ds_read_b64_tr_b16 v[16:17], v100 offset:0
    ds_read_b64_tr_b16 v[18:19], v100 offset:512
    ds_read_b64_tr_b16 v[20:21], v100 offset:4096
    ds_read_b64_tr_b16 v[22:23], v100 offset:4608
    ds_read_b64_tr_b16 v[24:25], v100 offset:8192
    ds_read_b64_tr_b16 v[26:27], v100 offset:8704
    ds_read_b64_tr_b16 v[28:29], v100 offset:12288
    ds_read_b64_tr_b16 v[30:31], v100 offset:12800
    ds_read_b64_tr_b16 v[32:33], v100 offset:16384
    ds_read_b64_tr_b16 v[34:35], v100 offset:16896
    s_lshl_b32 s4, s83, 2
    s_add_u32 s4, s4, s79
    s_lshl_b32 s4, s4, 7
    s_add_u32 s4, s4, 4096
    v_lshlrev_b32 v101, 6, v12
    v_lshl_add_u32 v101, v2, 4, v101
    v_add_u32 v101, s4, v101
    v_readfirstlane_b32 s88, v254
    v_readfirstlane_b32 s89, v255
    s_nop 3
    s_add_u32 s88, s88, 1
    s_addc_u32 s89, s89, 0
    s_waitcnt lgkmcnt(0)
    v_mfma_f32_16x16x32_bf16 v[76:79], v[16:19], v[110:113], 0
    v_mfma_f32_16x16x32_bf16 v[76:79], v[20:23], v[114:117], v[76:79]
    v_mfma_f32_16x16x32_bf16 v[76:79], v[24:27], v[118:121], v[76:79]
    v_mfma_f32_16x16x32_bf16 v[76:79], v[28:31], v[122:125], v[76:79]
    v_mfma_f32_16x16x32_bf16 v[76:79], v[32:35], v[126:129], v[76:79]
    v_mov_b32 v134, s88
    v_mov_b32 v135, s89
    s_nop 7
    v_cvt_pk_bf16_f32 v132, v76, v77
    v_cvt_pk_bf16_f32 v133, v78, v79
    s_mov_b32 exec_lo, 0x30003
    s_mov_b32 exec_hi, 0x30003
    buffer_store_dwordx4 v[132:135], v101, s[72:75], 0 offen offset:0 sc1
    s_mov_b64 exec, -1
    s_waitcnt vmcnt(1)
    s_branch L_f_stats
L_f_nop0c:
    s_waitcnt vmcnt(0)
L_f_stats:
    v_lshlrev_b32 v110, 16, v88
    v_and_b32 v111, 0xffff0000, v88
    v_lshlrev_b32 v112, 16, v89
    v_and_b32 v113, 0xffff0000, v89
    v_lshlrev_b32 v114, 16, v90
    v_and_b32 v115, 0xffff0000, v90
    v_lshlrev_b32 v116, 16, v91
    v_and_b32 v117, 0xffff0000, v91
    v_lshlrev_b32 v118, 16, v92
    v_and_b32 v119, 0xffff0000, v92
    v_lshlrev_b32 v120, 16, v93
    v_and_b32 v121, 0xffff0000, v93
    v_lshlrev_b32 v122, 16, v94
    v_and_b32 v123, 0xffff0000, v94
    v_lshlrev_b32 v124, 16, v95
    v_and_b32 v125, 0xffff0000, v95
    v_lshlrev_b32 v126, 16, v96
    v_and_b32 v127, 0xffff0000, v96
    v_lshlrev_b32 v128, 16, v97
    v_and_b32 v129, 0xffff0000, v97
    v_add_f32 v130, v110, v111
    v_add_f32 v130, v130, v112
    v_add_f32 v130, v130, v113
    v_add_f32 v130, v130, v114
    v_add_f32 v130, v130, v115
    v_add_f32 v130, v130, v116
    v_add_f32 v130, v130, v117
    v_add_f32 v130, v130, v118
    v_add_f32 v130, v130, v119
    v_add_f32 v130, v130, v120
    v_add_f32 v130, v130, v121
    v_add_f32 v130, v130, v122
    v_add_f32 v130, v130, v123
    v_add_f32 v130, v130, v124
    v_add_f32 v130, v130, v125
    v_add_f32 v130, v130, v126
    v_add_f32 v130, v130, v127
    v_add_f32 v130, v130, v128
    v_add_f32 v130, v130, v129
    s_nop 1
    v_add_f32_dpp v130, v130, v130 row_ror:8 row_mask:0xf bank_mask:0xf
    s_nop 1
    v_add_f32_dpp v130, v130, v130 row_ror:4 row_mask:0xf bank_mask:0xf
    s_nop 1
    v_add_f32_dpp v130, v130, v130 row_ror:2 row_mask:0xf bank_mask:0xf
    s_nop 1
    v_add_f32_dpp v130, v130, v130 row_ror:1 row_mask:0xf bank_mask:0xf
    v_mov_b32 v131, v130
    s_nop 1
    v_permlane16_swap_b32 v130, v131
    s_nop 1
    v_add_f32 v130, v130, v131
    v_mul_f32 v130, 0x3acccccd, v130
    v_sub_f32 v110, v110, v130
    v_sub_f32 v111, v111, v130
    v_sub_f32 v112, v112, v130
    v_sub_f32 v113, v113, v130
    v_sub_f32 v114, v114, v130
    v_sub_f32 v115, v115, v130
    v_sub_f32 v116, v116, v130
    v_sub_f32 v117, v117, v130
    v_sub_f32 v118, v118, v130
    v_sub_f32 v119, v119, v130
    v_sub_f32 v120, v120, v130
    v_sub_f32 v121, v121, v130
    v_sub_f32 v122, v122, v130
    v_sub_f32 v123, v123, v130
    v_sub_f32 v124, v124, v130
    v_sub_f32 v125, v125, v130
    v_sub_f32 v126, v126, v130
    v_sub_f32 v127, v127, v130
    v_sub_f32 v128, v128, v130
    v_sub_f32 v129, v129, v130
    v_mul_f32 v132, v110, v110
    v_fmac_f32 v132, v111, v111
    v_fmac_f32 v132, v112, v112
    v_fmac_f32 v132, v113, v113
    v_fmac_f32 v132, v114, v114
    v_fmac_f32 v132, v115, v115
    v_fmac_f32 v132, v116, v116
    v_fmac_f32 v132, v117, v117
    v_fmac_f32 v132, v118, v118
    v_fmac_f32 v132, v119, v119
    v_fmac_f32 v132, v120, v120
    v_fmac_f32 v132, v121, v121
    v_fmac_f32 v132, v122, v122
    v_fmac_f32 v132, v123, v123
    v_fmac_f32 v132, v124, v124
    v_fmac_f32 v132, v125, v125
    v_fmac_f32 v132, v126, v126
    v_fmac_f32 v132, v127, v127
    v_fmac_f32 v132, v128, v128
    v_fmac_f32 v132, v129, v129
    s_nop 1
    v_add_f32_dpp v132, v132, v132 row_ror:8 row_mask:0xf bank_mask:0xf
    s_nop 1
    v_add_f32_dpp v132, v132, v132 row_ror:4 row_mask:0xf bank_mask:0xf
    s_nop 1
    v_add_f32_dpp v132, v132, v132 row_ror:2 row_mask:0xf bank_mask:0xf
    s_nop 1
    v_add_f32_dpp v132, v132, v132 row_ror:1 row_mask:0xf bank_mask:0xf
    v_mov_b32 v131, v132
    s_nop 1
    v_permlane16_swap_b32 v132, v131
    s_nop 1
    v_add_f32 v132, v132, v131
    v_mov_b32 v131, 0x3727c5ac
    v_fmac_f32 v131, 0x3acccccd, v132
    v_rsq_f32 v131, v131
    s_nop 1
    v_readlane_b32 s8, v130, 0
    v_readlane_b32 s9, v130, 32
    v_readlane_b32 s10, v131, 0
    v_readlane_b32 s11, v131, 32
    v_lshlrev_b32 v150, 16, v104
    v_and_b32 v151, 0xffff0000, v104
    v_lshlrev_b32 v152, 16, v105
    v_and_b32 v153, 0xffff0000, v105
    v_lshlrev_b32 v154, 16, v106
    v_and_b32 v155, 0xffff0000, v106
    v_lshlrev_b32 v156, 16, v107
    v_and_b32 v157, 0xffff0000, v107
    v_subrev_f32 v150, s8, v150
    v_mul_f32 v150, s10, v150
    v_subrev_f32 v151, s8, v151
    v_mul_f32 v151, s10, v151
    v_subrev_f32 v152, s8, v152
    v_mul_f32 v152, s10, v152
    v_subrev_f32 v153, s8, v153
    v_mul_f32 v153, s10, v153
    v_subrev_f32 v154, s9, v154
    v_mul_f32 v154, s11, v154
    v_subrev_f32 v155, s9, v155
    v_mul_f32 v155, s11, v155
    v_subrev_f32 v156, s9, v156
    v_mul_f32 v156, s11, v156
    v_subrev_f32 v157, s9, v157
    v_mul_f32 v157, s11, v157
    s_barrier
    v_add_u32 v100, 0, v11
    ds_read_b64_tr_b16 v[36:37], v100 offset:0
    ds_read_b64_tr_b16 v[38:39], v100 offset:1024
    ds_read_b64_tr_b16 v[40:41], v100 offset:32
    ds_read_b64_tr_b16 v[42:43], v100 offset:1056
    ds_read_b64_tr_b16 v[44:45], v100 offset:8192
    ds_read_b64_tr_b16 v[46:47], v100 offset:9216
    ds_read_b64_tr_b16 v[48:49], v100 offset:8224
    ds_read_b64_tr_b16 v[50:51], v100 offset:9248
    ds_read_b64_tr_b16 v[52:53], v100 offset:16384
    ds_read_b64_tr_b16 v[54:55], v100 offset:17408
    ds_read_b64_tr_b16 v[56:57], v100 offset:16416
    ds_read_b64_tr_b16 v[58:59], v100 offset:17440
    ds_read_b64_tr_b16 v[60:61], v100 offset:24576
    ds_read_b64_tr_b16 v[62:63], v100 offset:25600
    ds_read_b64_tr_b16 v[64:65], v100 offset:24608
    ds_read_b64_tr_b16 v[66:67], v100 offset:25632
    ds_read_b64_tr_b16 v[68:69], v100 offset:32768
    ds_read_b64_tr_b16 v[70:71], v100 offset:33792
    ds_read_b64_tr_b16 v[72:73], v100 offset:32800
    ds_read_b64_tr_b16 v[74:75], v100 offset:33824
    v_readfirstlane_b32 s88, v254
    v_readfirstlane_b32 s89, v255
    s_nop 3
    s_add_u32 s88, s88, 1
    s_addc_u32 s89, s89, 0
    s_mul_i32 s5, s91, 40
    v_add_u32 v103, s5, v14
    v_lshrrev_b32 v100, 4, v103
    v_lshlrev_b32 v100, 11, v100
    v_bfe_u32 v106, v103, 2, 2
    v_lshl_add_u32 v100, v106, 7, v100
    v_and_b32 v106, 3, v103
    v_lshl_add_u32 v100, v106, 4, v100
    s_lshl_b32 s4, s79, 9
    s_add_u32 s4, s4, 4096
    v_add_u32 v100, s4, v100
    v_add_u32 v104, 20480, v100
    v_lshlrev_b32 v102, 3, v14
    s_mul_i32 s4, s79, 672
    s_add_u32 s4, s4, 61440
    v_add_u32 v102, s4, v102
    v_mul_u32_u24 v108, 336, v13
    v_lshl_add_u32 v108, v2, 4, v108
    v_add_u32 v108, 61440, v108
    v_lshlrev_b32 v105, 6, v12
    v_bfe_u32 v106, v1, 1, 1
    v_lshl_add_u32 v105, v106, 5, v105
    v_lshl_add_u32 v105, v2, 3, v105
    s_lshl_b32 s4, s81, 2
    s_add_u32 s4, s4, s91
    s_lshl_b32 s4, s4, 2
    s_add_u32 s4, s4, s79
    s_lshl_b32 s4, s4, 7
    s_add_u32 s4, s4, 65536
    v_add_u32 v105, s4, v105
    v_cmp_eq_u32 s[10:11], 1, v106
    s_cmp_eq_u32 s79, 0
    s_cselect_b32 s8, 1.0, 0
    v_lshlrev_b32 v101, 4, v0
    s_mov_b32 s96, 31
L_gp_3:
    s_bitcmp1_b32 s96, 0
    s_cbranch_scc0 L_gs__5
    buffer_load_dwordx4 v[110:113], v100, s[72:75], 0 offen offset:0 sc1
L_gs__5:
    s_bitcmp1_b32 s96, 1
    s_cbranch_scc0 L_gs__6
    buffer_load_dwordx4 v[114:117], v104, s[72:75], 0 offen offset:0 sc1
L_gs__6:
    s_bitcmp1_b32 s96, 2
    s_cbranch_scc0 L_gs__7
    buffer_load_dwordx4 v[118:121], v100, s[72:75], 0 offen offset:64 sc1
L_gs__7:
    s_bitcmp1_b32 s96, 3
    s_cbranch_scc0 L_gs__8
    buffer_load_dwordx4 v[122:125], v104, s[72:75], 0 offen offset:64 sc1
L_gs__8:
    s_bitcmp1_b32 s96, 4
    s_cbranch_scc0 L_gs__9
    buffer_load_dword v126, v101, s[72:75], 0 offen offset:0 sc1
    buffer_load_dword v127, v101, s[72:75], 0 offen offset:1024 sc1
L_gs__9:
    s_waitcnt vmcnt(0)
    s_bitcmp1_b32 s96, 0
    s_cbranch_scc0 L_gc__10
    v_xor_b32 v103, s88, v112
    v_xor_b32 v106, s89, v113
    v_or_b32 v103, v103, v106
    v_cmp_ne_u32 vcc, 0, v103
    s_cbranch_vccnz L_gc__10
    s_bitset0_b32 s96, 0
L_gc__10:
    s_bitcmp1_b32 s96, 1
    s_cbranch_scc0 L_gc__11
    v_xor_b32 v103, s88, v116
    v_xor_b32 v106, s89, v117
    v_or_b32 v103, v103, v106
    v_cmp_ne_u32 vcc, 0, v103
    s_cbranch_vccnz L_gc__11
    s_bitset0_b32 s96, 1
L_gc__11:
    s_bitcmp1_b32 s96, 2
    s_cbranch_scc0 L_gc__12
    v_xor_b32 v103, s88, v120
    v_xor_b32 v106, s89, v121
    v_or_b32 v103, v103, v106
    v_cmp_ne_u32 vcc, 0, v103
    s_cbranch_vccnz L_gc__12
    s_bitset0_b32 s96, 2
L_gc__12:
    s_bitcmp1_b32 s96, 3
    s_cbranch_scc0 L_gc__13
    v_xor_b32 v103, s88, v124
    v_xor_b32 v106, s89, v125
    v_or_b32 v103, v103, v106
    v_cmp_ne_u32 vcc, 0, v103
    s_cbranch_vccnz L_gc__13
    s_bitset0_b32 s96, 3
L_gc__13:
    s_bitcmp1_b32 s96, 4
    s_cbranch_scc0 L_gc__14
    v_xor_b32 v103, s88, v126
    v_xor_b32 v106, s88, v127
    v_or_b32 v103, v103, v106
    v_cmp_ne_u32 vcc, 0, v103
    s_cbranch_vccnz L_gc__14
    s_bitset0_b32 s96, 4
L_gc__14:
    s_cmp_eq_u32 s96, 0
    s_cbranch_scc1 L_gp_done_4
    s_add_u32 s87, s87, 1
    s_cmp_lt_u32 s87, 400000
    s_cbranch_scc1 L_gp_3
    s_branch L_bail
L_gp_done_4:
    v_lshlrev_b32 v130, 16, v114
    v_and_b32 v131, 0xffff0000, v114
    v_lshlrev_b32 v132, 16, v115
    v_and_b32 v133, 0xffff0000, v115
    v_lshlrev_b32 v134, 16, v110
    v_and_b32 v135, 0xffff0000, v110
    v_lshlrev_b32 v136, 16, v111
    v_and_b32 v137, 0xffff0000, v111
    v_add_f32 v130, s8, v130
    v_add_f32 v131, s8, v131
    v_add_f32 v132, s8, v132
    v_add_f32 v133, s8, v133
    v_fma_f32 v130, v150, v130, v134
    v_fma_f32 v131, v151, v131, v135
    v_fma_f32 v132, v152, v132, v136
    v_fma_f32 v133, v153, v133, v137
    v_cvt_pk_bf16_f32 v146, v130, v131
    v_cvt_pk_bf16_f32 v147, v132, v133
    ds_write_b64 v102, v[146:147] offset:0
    v_lshlrev_b32 v138, 16, v122
    v_and_b32 v139, 0xffff0000, v122
    v_lshlrev_b32 v140, 16, v123
    v_and_b32 v141, 0xffff0000, v123
    v_lshlrev_b32 v142, 16, v118
    v_and_b32 v143, 0xffff0000, v118
    v_lshlrev_b32 v144, 16, v119
    v_and_b32 v145, 0xffff0000, v119
    v_add_f32 v138, s8, v138
    v_add_f32 v139, s8, v139
    v_add_f32 v140, s8, v140
    v_add_f32 v141, s8, v141
    v_fma_f32 v138, v154, v138, v142
    v_fma_f32 v139, v155, v139, v143
    v_fma_f32 v140, v156, v140, v144
    v_fma_f32 v141, v157, v141, v145
    v_cvt_pk_bf16_f32 v148, v138, v139
    v_cvt_pk_bf16_f32 v149, v140, v141
    ds_write_b64 v102, v[148:149] offset:336
    s_waitcnt lgkmcnt(0)
    s_barrier
    ds_read_b128 v[110:113], v108 offset:0
    ds_read_b128 v[114:117], v108 offset:64
    ds_read_b128 v[118:121], v108 offset:128
    ds_read_b128 v[122:125], v108 offset:192
    ds_read_b128 v[126:129], v108 offset:256
    s_waitcnt lgkmcnt(0)
    v_mfma_f32_16x16x32_bf16 v[76:79], v[36:39], v[110:113], 0
    v_mfma_f32_16x16x32_bf16 v[80:83], v[40:43], v[110:113], 0
    v_mfma_f32_16x16x32_bf16 v[76:79], v[44:47], v[114:117], v[76:79]
    v_mfma_f32_16x16x32_bf16 v[80:83], v[48:51], v[114:117], v[80:83]
    v_mfma_f32_16x16x32_bf16 v[76:79], v[52:55], v[118:121], v[76:79]
    v_mfma_f32_16x16x32_bf16 v[80:83], v[56:59], v[118:121], v[80:83]
    v_mfma_f32_16x16x32_bf16 v[76:79], v[60:63], v[122:125], v[76:79]
    v_mfma_f32_16x16x32_bf16 v[80:83], v[64:67], v[122:125], v[80:83]
    v_mfma_f32_16x16x32_bf16 v[76:79], v[68:71], v[126:129], v[76:79]
    v_mfma_f32_16x16x32_bf16 v[80:83], v[72:75], v[126:129], v[80:83]
    s_nop 7
    s_nop 1
    v_add_f32_dpp v76, v76, v76 row_ror:2 row_mask:0xf bank_mask:0xf
    v_add_f32_dpp v77, v77, v77 row_ror:2 row_mask:0xf bank_mask:0xf
    v_add_f32_dpp v78, v78, v78 row_ror:2 row_mask:0xf bank_mask:0xf
    v_add_f32_dpp v79, v79, v79 row_ror:2 row_mask:0xf bank_mask:0xf
    v_add_f32_dpp v80, v80, v80 row_ror:2 row_mask:0xf bank_mask:0xf
    v_add_f32_dpp v81, v81, v81 row_ror:2 row_mask:0xf bank_mask:0xf
    v_add_f32_dpp v82, v82, v82 row_ror:2 row_mask:0xf bank_mask:0xf
    v_add_f32_dpp v83, v83, v83 row_ror:2 row_mask:0xf bank_mask:0xf
    v_add_f32_dpp v76, v76, v76 row_ror:4 row_mask:0xf bank_mask:0xf
    v_add_f32_dpp v77, v77, v77 row_ror:4 row_mask:0xf bank_mask:0xf
    v_add_f32_dpp v78, v78, v78 row_ror:4 row_mask:0xf bank_mask:0xf
    v_add_f32_dpp v79, v79, v79 row_ror:4 row_mask:0xf bank_mask:0xf
    v_add_f32_dpp v80, v80, v80 row_ror:4 row_mask:0xf bank_mask:0xf
    v_add_f32_dpp v81, v81, v81 row_ror:4 row_mask:0xf bank_mask:0xf
    v_add_f32_dpp v82, v82, v82 row_ror:4 row_mask:0xf bank_mask:0xf
    v_add_f32_dpp v83, v83, v83 row_ror:4 row_mask:0xf bank_mask:0xf
    v_cvt_pk_bf16_f32 v130, v76, v77
    v_cvt_pk_bf16_f32 v131, v78, v79
    v_or_b32 v130, 1, v130
    v_cvt_pk_bf16_f32 v132, v80, v81
    v_cvt_pk_bf16_f32 v133, v82, v83
    v_or_b32 v132, 1, v132
    v_cndmask_b32 v130, v130, v132, s[10:11]
    v_cndmask_b32 v131, v131, v133, s[10:11]
    s_mov_b32 exec_lo, 0xf000f
    s_mov_b32 exec_hi, 0xf000f
    buffer_store_dwordx2 v[130:131], v105, s[72:75], 0 offen offset:0 sc1
    s_mov_b64 exec, -1
    s_branch L_wave_end
L_g1:
    s_sleep 2
    s_mul_i32 s5, s91, 160
    s_mul_i32 s6, s79, 40
    s_add_u32 s5, s5, s6
    v_add_u32 v100, s5, v2
    v_lshlrev_b32 v100, 13, v100
    v_lshl_add_u32 v100, v1, 4, v100
    s_lshl_b32 s5, s81, 8
    v_add_u32 v100, s5, v100
    s_mul_i32 s5, s79, 10240
    s_add_u32 s5, s5, 0
    s_mov_b32 m0, s5
    s_nop 0
    buffer_load_dwordx4 v100, s[24:27], 0 offen nt lds
    s_add_u32 s5, s5, 1024
    s_mov_b32 m0, s5
    v_add_u32 v100, 32768, v100
    buffer_load_dwordx4 v100, s[24:27], 0 offen nt lds
    s_add_u32 s5, s5, 1024
    s_mov_b32 m0, s5
    v_add_u32 v100, 32768, v100
    buffer_load_dwordx4 v100, s[24:27], 0 offen nt lds
    s_add_u32 s5, s5, 1024
    s_mov_b32 m0, s5
    v_add_u32 v100, 32768, v100
    buffer_load_dwordx4 v100, s[24:27], 0 offen nt lds
    s_add_u32 s5, s5, 1024
    s_mov_b32 m0, s5
    v_add_u32 v100, 32768, v100
    buffer_load_dwordx4 v100, s[24:27], 0 offen nt lds
    s_add_u32 s5, s5, 1024
    s_mov_b32 m0, s5
    v_add_u32 v100, 32768, v100
    buffer_load_dwordx4 v100, s[24:27], 0 offen nt lds
    s_add_u32 s5, s5, 1024
    s_mov_b32 m0, s5
    v_add_u32 v100, 32768, v100
    buffer_load_dwordx4 v100, s[24:27], 0 offen nt lds
    s_add_u32 s5, s5, 1024
    s_mov_b32 m0, s5
    v_add_u32 v100, 32768, v100
    buffer_load_dwordx4 v100, s[24:27], 0 offen nt lds
    s_add_u32 s5, s5, 1024
    s_mov_b32 m0, s5
    v_add_u32 v100, 32768, v100
    buffer_load_dwordx4 v100, s[24:27], 0 offen nt lds
    s_add_u32 s5, s5, 1024
    s_mov_b32 m0, s5
    v_add_u32 v100, 32768, v100
    buffer_load_dwordx4 v100, s[24:27], 0 offen nt lds
    s_barrier
    s_sleep 30
    s_lshl_b32 s6, s91, 7
    s_lshl_b32 s7, s79, 5
    s_add_u32 s6, s6, s7
    v_add_u32 v100, s6, v1
    v_lshlrev_b32 v100, 13, v100
    v_lshl_add_u32 v100, v2, 4, v100
    s_lshl_b32 s6, s81, 8
    v_add_u32 v100, s6, v100
    v_add_u32 v101, 131072, v100
    buffer_load_dwordx4 v[16:19], v100, s[28:31], 0 offen offset:0 nt
    buffer_load_dwordx4 v[20:23], v100, s[28:31], 0 offen offset:64 nt
    buffer_load_dwordx4 v[24:27], v100, s[28:31], 0 offen offset:128 nt
    buffer_load_dwordx4 v[28:31], v100, s[28:31], 0 offen offset:192 nt
    buffer_load_dwordx4 v[32:35], v101, s[28:31], 0 offen offset:0 nt
    buffer_load_dwordx4 v[36:39], v101, s[28:31], 0 offen offset:64 nt
    buffer_load_dwordx4 v[40:43], v101, s[28:31], 0 offen offset:128 nt
    buffer_load_dwordx4 v[44:47], v101, s[28:31], 0 offen offset:192 nt
    v_lshrrev_b32 v100, 1, v13
    v_lshlrev_b32 v100, 9, v100
    v_lshl_add_u32 v100, v12, 6, v100
    v_lshl_add_u32 v100, v2, 4, v100
    s_lshl_b32 s4, s81, 11
    s_add_u32 s4, s4, 65536
    v_add_u32 v100, s4, v100
    v_lshlrev_b32 v101, 15, v12
    v_bfe_u32 v106, v1, 1, 1
    v_lshl_add_u32 v101, v106, 5, v101
    v_lshl_add_u32 v101, v2, 3, v101
    s_lshl_b32 s4, s81, 10
    s_lshl_b32 s5, s91, 8
    s_add_u32 s4, s4, s5
    s_lshl_b32 s5, s79, 6
    s_add_u32 s4, s4, s5
    s_add_u32 s4, s4, 131072
    v_add_u32 v101, s4, v101
    v_cmp_eq_u32 s[10:11], 1, v106
    s_waitcnt vmcnt(8)
    s_barrier
    s_waitcnt vmcnt(0)
    v_readfirstlane_b32 s88, v254
    v_readfirstlane_b32 s89, v255
    s_nop 3
    s_add_u32 s88, s88, 1
    s_addc_u32 s89, s89, 0
    v_lshlrev_b32 v102, 4, v0
L_g1f:
    buffer_load_dword v110, v102, s[72:75], 0 offen offset:0 sc1
    buffer_load_dword v111, v102, s[72:75], 0 offen offset:1024 sc1
    s_waitcnt vmcnt(0)
    v_xor_b32 v110, s88, v110
    v_xor_b32 v111, s88, v111
    v_or_b32 v110, v110, v111
    v_cmp_ne_u32 vcc, 0, v110
    s_cbranch_vccz L_g1f_done
    s_sleep 4
    s_add_u32 s87, s87, 1
    s_cmp_lt_u32 s87, 400000
    s_cbranch_scc1 L_g1f
    s_branch L_bail
L_g1f_done:
    s_barrier
    s_mov_b32 s96, 15
L_gp_15:
    s_bitcmp1_b32 s96, 0
    s_cbranch_scc0 L_gs__17
    buffer_load_dwordx4 v[84:87], v100, s[72:75], 0 offen offset:0 sc1
L_gs__17:
    s_bitcmp1_b32 s96, 1
    s_cbranch_scc0 L_gs__18
    buffer_load_dwordx4 v[88:91], v100, s[72:75], 0 offen offset:128 sc1
L_gs__18:
    s_bitcmp1_b32 s96, 2
    s_cbranch_scc0 L_gs__19
    buffer_load_dwordx4 v[92:95], v100, s[72:75], 0 offen offset:256 sc1
L_gs__19:
    s_bitcmp1_b32 s96, 3
    s_cbranch_scc0 L_gs__20
    buffer_load_dwordx4 v[96:99], v100, s[72:75], 0 offen offset:384 sc1
L_gs__20:
    s_waitcnt vmcnt(0)
    s_bitcmp1_b32 s96, 0
    s_cbranch_scc0 L_gc__21
    v_and_b32 v103, v84, v86
    v_and_b32 v103, 1, v103
    v_cmp_eq_u32 vcc, 0, v103
    s_cbranch_vccnz L_gc__21
    s_bitset0_b32 s96, 0
L_gc__21:
    s_bitcmp1_b32 s96, 1
    s_cbranch_scc0 L_gc__22
    v_and_b32 v103, v88, v90
    v_and_b32 v103, 1, v103
    v_cmp_eq_u32 vcc, 0, v103
    s_cbranch_vccnz L_gc__22
    s_bitset0_b32 s96, 1
L_gc__22:
    s_bitcmp1_b32 s96, 2
    s_cbranch_scc0 L_gc__23
    v_and_b32 v103, v92, v94
    v_and_b32 v103, 1, v103
    v_cmp_eq_u32 vcc, 0, v103
    s_cbranch_vccnz L_gc__23
    s_bitset0_b32 s96, 2
L_gc__23:
    s_bitcmp1_b32 s96, 3
    s_cbranch_scc0 L_gc__24
    v_and_b32 v103, v96, v98
    v_and_b32 v103, 1, v103
    v_cmp_eq_u32 vcc, 0, v103
    s_cbranch_vccnz L_gc__24
    s_bitset0_b32 s96, 3
L_gc__24:
    s_cmp_eq_u32 s96, 0
    s_cbranch_scc1 L_gp_done_16
    s_add_u32 s87, s87, 1
    s_cmp_lt_u32 s87, 400000
    s_cbranch_scc1 L_gp_15
    s_branch L_bail
L_gp_done_16:
    v_mfma_f32_16x16x32_bf16 v[76:79], v[16:19], v[84:87], 0
    v_mfma_f32_16x16x32_bf16 v[80:83], v[32:35], v[84:87], 0
    v_mfma_f32_16x16x32_bf16 v[76:79], v[20:23], v[88:91], v[76:79]
    v_mfma_f32_16x16x32_bf16 v[80:83], v[36:39], v[88:91], v[80:83]
    v_mfma_f32_16x16x32_bf16 v[76:79], v[24:27], v[92:95], v[76:79]
    v_mfma_f32_16x16x32_bf16 v[80:83], v[40:43], v[92:95], v[80:83]
    v_mfma_f32_16x16x32_bf16 v[76:79], v[28:31], v[96:99], v[76:79]
    v_mfma_f32_16x16x32_bf16 v[80:83], v[44:47], v[96:99], v[80:83]
    s_mov_b32 s8, 0x3e0293ee
    s_nop 7
    s_nop 0
    v_add_f32_dpp v76, v76, v76 row_ror:2 row_mask:0xf bank_mask:0xf
    v_add_f32_dpp v77, v77, v77 row_ror:2 row_mask:0xf bank_mask:0xf
    v_add_f32_dpp v78, v78, v78 row_ror:2 row_mask:0xf bank_mask:0xf
    v_add_f32_dpp v79, v79, v79 row_ror:2 row_mask:0xf bank_mask:0xf
    v_add_f32_dpp v80, v80, v80 row_ror:2 row_mask:0xf bank_mask:0xf
    v_add_f32_dpp v81, v81, v81 row_ror:2 row_mask:0xf bank_mask:0xf
    v_add_f32_dpp v82, v82, v82 row_ror:2 row_mask:0xf bank_mask:0xf
    v_add_f32_dpp v83, v83, v83 row_ror:2 row_mask:0xf bank_mask:0xf
    v_add_f32_dpp v76, v76, v76 row_ror:4 row_mask:0xf bank_mask:0xf
    v_add_f32_dpp v77, v77, v77 row_ror:4 row_mask:0xf bank_mask:0xf
    v_add_f32_dpp v78, v78, v78 row_ror:4 row_mask:0xf bank_mask:0xf
    v_add_f32_dpp v79, v79, v79 row_ror:4 row_mask:0xf bank_mask:0xf
    v_add_f32_dpp v80, v80, v80 row_ror:4 row_mask:0xf bank_mask:0xf
    v_add_f32_dpp v81, v81, v81 row_ror:4 row_mask:0xf bank_mask:0xf
    v_add_f32_dpp v82, v82, v82 row_ror:4 row_mask:0xf bank_mask:0xf
    v_add_f32_dpp v83, v83, v83 row_ror:4 row_mask:0xf bank_mask:0xf
    v_mul_f32 v110, s8, v76
    v_mul_f32 v111, s8, v77
    v_mul_f32 v112, s8, v78
    v_mul_f32 v113, s8, v79
    v_mul_f32 v114, s8, v80
    v_mul_f32 v115, s8, v81
    v_mul_f32 v116, s8, v82
    v_mul_f32 v117, s8, v83
    v_cvt_pk_bf16_f32 v104, v110, v111
    v_cvt_pk_bf16_f32 v105, v112, v113
    v_or_b32 v104, 1, v104
    v_cvt_pk_bf16_f32 v106, v114, v115
    v_cvt_pk_bf16_f32 v107, v116, v117
    v_or_b32 v106, 1, v106
    v_cndmask_b32 v104, v104, v106, s[10:11]
    v_cndmask_b32 v105, v105, v107, s[10:11]
    s_mov_b32 exec_lo, 0xf000f
    s_mov_b32 exec_hi, 0xf000f
    buffer_store_dwordx2 v[104:105], v101, s[72:75], 0 offen offset:0 sc1
    s_mov_b64 exec, -1
    s_lshl_b32 s4, s79, 12
    s_add_u32 s4, s4, 69632
    v_lshlrev_b32 v5, 3, v0
    v_add_u32 v5, s4, v5
    v_lshrrev_b32 v8, 1, v0
    v_bfe_u32 v9, v8, 2, 1
    v_lshlrev_b32 v9, 4, v9
    v_lshrrev_b32 v10, 3, v8
    v_lshl_add_u32 v9, v10, 2, v9
    v_and_b32 v10, 3, v8
    v_add_u32 v9, v9, v10
    v_and_b32 v10, 1, v0
    v_lshlrev_b32 v11, 4, v10
    v_lshl_add_u32 v4, v9, 5, v11
    v_add_u32 v4, s4, v4
    v_lshlrev_b32 v6, 4, v0
    v_add_u32 v6, s4, v6
    v_lshrrev_b32 v12, 2, v0
    v_lshlrev_b32 v7, 6, v12
    v_and_b32 v13, 3, v0
    v_lshl_add_u32 v7, v13, 3, v7
    v_add_u32 v7, s4, v7
    v_and_b32 v12, 3, v12
    v_lshl_add_u32 v12, v2, 3, v12
    v_lshlrev_b32 v15, 7, v12
    v_lshl_add_u32 v15, v13, 3, v15
    v_add_u32 v15, s4, v15
    v_lshlrev_b32 v13, 4, v13
    s_mul_i32 s91, s76, 5
    s_add_u32 s92, s91, s80
    s_sub_u32 s94, s92, 10
    s_sub_u32 s92, s92, 5
    s_add_u32 s91, s91, s80
    s_mul_i32 s93, s76, 7
    s_add_u32 s93, s93, s80
    s_sub_u32 s93, s93, 9
    s_cmp_ge_u32 s80, 5
    s_cbranch_scc1 L_b_r2
    s_and_b32 s6, s91, 3
    s_lshl_b32 s6, s6, 10
    s_lshl_b32 s7, s79, 8
    s_add_u32 s6, s6, s7
    s_lshr_b32 s7, s91, 2
    s_lshl_b32 s7, s7, 7
    v_lshrrev_b32 v204, 3, v0
    v_add_u32 v204, s6, v204
    s_movk_i32 s5, 1280
    v_mul_lo_u32 v204, v204, s5
    v_and_b32 v205, 7, v0
    v_lshl_add_u32 v204, v205, 4, v204
    v_add_u32 v204, s7, v204
    buffer_load_dwordx4 v[48:51], v204, s[36:39], 0 offen offset:0 nt
    v_add_u32 v204, 10240, v204
    buffer_load_dwordx4 v[52:55], v204, s[36:39], 0 offen offset:0 nt
    v_add_u32 v204, 10240, v204
    buffer_load_dwordx4 v[56:59], v204, s[36:39], 0 offen offset:0 nt
    v_add_u32 v204, 10240, v204
    buffer_load_dwordx4 v[60:63], v204, s[36:39], 0 offen offset:0 nt
    v_add_u32 v204, 10240, v204
    buffer_load_dwordx4 v[64:67], v204, s[36:39], 0 offen offset:0 nt
    v_add_u32 v204, 10240, v204
    buffer_load_dwordx4 v[68:71], v204, s[36:39], 0 offen offset:0 nt
    v_add_u32 v204, 10240, v204
    buffer_load_dwordx4 v[72:75], v204, s[36:39], 0 offen offset:0 nt
    v_add_u32 v204, 10240, v204
    buffer_load_dwordx4 v[76:79], v204, s[36:39], 0 offen offset:0 nt
    v_add_u32 v204, 10240, v204
    buffer_load_dwordx4 v[80:83], v204, s[36:39], 0 offen offset:0 nt
    v_add_u32 v204, 10240, v204
    buffer_load_dwordx4 v[84:87], v204, s[36:39], 0 offen offset:0 nt
    v_add_u32 v204, 10240, v204
    buffer_load_dwordx4 v[88:91], v204, s[36:39], 0 offen offset:0 nt
    v_add_u32 v204, 10240, v204
    buffer_load_dwordx4 v[92:95], v204, s[36:39], 0 offen offset:0 nt
    v_add_u32 v204, 10240, v204
    buffer_load_dwordx4 v[96:99], v204, s[36:39], 0 offen offset:0 nt
    v_add_u32 v204, 10240, v204
    buffer_load_dwordx4 v[100:103], v204, s[36:39], 0 offen offset:0 nt
    v_add_u32 v204, 10240, v204
    buffer_load_dwordx4 v[104:107], v204, s[36:39], 0 offen offset:0 nt
    v_add_u32 v204, 10240, v204
    buffer_load_dwordx4 v[108:111], v204, s[36:39], 0 offen offset:0 nt
    v_add_u32 v204, 10240, v204
    buffer_load_dwordx4 v[112:115], v204, s[36:39], 0 offen offset:0 nt
    v_add_u32 v204, 10240, v204
    buffer_load_dwordx4 v[116:119], v204, s[36:39], 0 offen offset:0 nt
    v_add_u32 v204, 10240, v204
    buffer_load_dwordx4 v[120:123], v204, s[36:39], 0 offen offset:0 nt
    v_add_u32 v204, 10240, v204
    buffer_load_dwordx4 v[124:127], v204, s[36:39], 0 offen offset:0 nt
    v_add_u32 v204, 10240, v204
    buffer_load_dwordx4 v[128:131], v204, s[36:39], 0 offen offset:0 nt
    v_add_u32 v204, 10240, v204
    buffer_load_dwordx4 v[132:135], v204, s[36:39], 0 offen offset:0 nt
    v_add_u32 v204, 10240, v204
    buffer_load_dwordx4 v[136:139], v204, s[36:39], 0 offen offset:0 nt
    v_add_u32 v204, 10240, v204
    buffer_load_dwordx4 v[140:143], v204, s[36:39], 0 offen offset:0 nt
    v_add_u32 v204, 10240, v204
    buffer_load_dwordx4 v[144:147], v204, s[36:39], 0 offen offset:0 nt
    v_add_u32 v204, 10240, v204
    buffer_load_dwordx4 v[148:151], v204, s[36:39], 0 offen offset:0 nt
    v_add_u32 v204, 10240, v204
    buffer_load_dwordx4 v[152:155], v204, s[36:39], 0 offen offset:0 nt
    v_add_u32 v204, 10240, v204
    buffer_load_dwordx4 v[156:159], v204, s[36:39], 0 offen offset:0 nt
    v_add_u32 v204, 10240, v204
    buffer_load_dwordx4 v[160:163], v204, s[36:39], 0 offen offset:0 nt
    v_add_u32 v204, 10240, v204
    buffer_load_dwordx4 v[164:167], v204, s[36:39], 0 offen offset:0 nt
    v_add_u32 v204, 10240, v204
    buffer_load_dwordx4 v[168:171], v204, s[36:39], 0 offen offset:0 nt
    v_add_u32 v204, 10240, v204
    buffer_load_dwordx4 v[172:175], v204, s[36:39], 0 offen offset:0 nt
    s_waitcnt vmcnt(28)
    ds_write_b128 v6, v[48:51] offset:0
    ds_write_b128 v6, v[52:55] offset:1024
    ds_write_b128 v6, v[56:59] offset:2048
    ds_write_b128 v6, v[60:63] offset:3072
    ds_read_b64_tr_b16 v[48:49], v15 offset:0
    ds_read_b64_tr_b16 v[50:51], v15 offset:512
    ds_read_b64_tr_b16 v[52:53], v15 offset:32
    ds_read_b64_tr_b16 v[54:55], v15 offset:544
    ds_read_b64_tr_b16 v[56:57], v15 offset:64
    ds_read_b64_tr_b16 v[58:59], v15 offset:576
    ds_read_b64_tr_b16 v[60:61], v15 offset:96
    ds_read_b64_tr_b16 v[62:63], v15 offset:608
    s_waitcnt vmcnt(24)
    ds_write_b128 v6, v[64:67] offset:0
    ds_write_b128 v6, v[68:71] offset:1024
    ds_write_b128 v6, v[72:75] offset:2048
    ds_write_b128 v6, v[76:79] offset:3072
    ds_read_b64_tr_b16 v[64:65], v15 offset:0
    ds_read_b64_tr_b16 v[66:67], v15 offset:512
    ds_read_b64_tr_b16 v[68:69], v15 offset:32
    ds_read_b64_tr_b16 v[70:71], v15 offset:544
    ds_read_b64_tr_b16 v[72:73], v15 offset:64
    ds_read_b64_tr_b16 v[74:75], v15 offset:576
    ds_read_b64_tr_b16 v[76:77], v15 offset:96
    ds_read_b64_tr_b16 v[78:79], v15 offset:608
    s_waitcnt vmcnt(20)
    ds_write_b128 v6, v[80:83] offset:0
    ds_write_b128 v6, v[84:87] offset:1024
    ds_write_b128 v6, v[88:91] offset:2048
    ds_write_b128 v6, v[92:95] offset:3072
    ds_read_b64_tr_b16 v[80:81], v15 offset:0
    ds_read_b64_tr_b16 v[82:83], v15 offset:512
    ds_read_b64_tr_b16 v[84:85], v15 offset:32
    ds_read_b64_tr_b16 v[86:87], v15 offset:544
    ds_read_b64_tr_b16 v[88:89], v15 offset:64
    ds_read_b64_tr_b16 v[90:91], v15 offset:576
    ds_read_b64_tr_b16 v[92:93], v15 offset:96
    ds_read_b64_tr_b16 v[94:95], v15 offset:608
    s_waitcnt vmcnt(16)
    ds_write_b128 v6, v[96:99] offset:0
    ds_write_b128 v6, v[100:103] offset:1024
    ds_write_b128 v6, v[104:107] offset:2048
    ds_write_b128 v6, v[108:111] offset:3072
    ds_read_b64_tr_b16 v[96:97], v15 offset:0
    ds_read_b64_tr_b16 v[98:99], v15 offset:512
    ds_read_b64_tr_b16 v[100:101], v15 offset:32
    ds_read_b64_tr_b16 v[102:103], v15 offset:544
    ds_read_b64_tr_b16 v[104:105], v15 offset:64
    ds_read_b64_tr_b16 v[106:107], v15 offset:576
    ds_read_b64_tr_b16 v[108:109], v15 offset:96
    ds_read_b64_tr_b16 v[110:111], v15 offset:608
    s_waitcnt vmcnt(12)
    ds_write_b128 v6, v[112:115] offset:0
    ds_write_b128 v6, v[116:119] offset:1024
    ds_write_b128 v6, v[120:123] offset:2048
    ds_write_b128 v6, v[124:127] offset:3072
    ds_read_b64_tr_b16 v[112:113], v15 offset:0
    ds_read_b64_tr_b16 v[114:115], v15 offset:512
    ds_read_b64_tr_b16 v[116:117], v15 offset:32
    ds_read_b64_tr_b16 v[118:119], v15 offset:544
    ds_read_b64_tr_b16 v[120:121], v15 offset:64
    ds_read_b64_tr_b16 v[122:123], v15 offset:576
    ds_read_b64_tr_b16 v[124:125], v15 offset:96
    ds_read_b64_tr_b16 v[126:127], v15 offset:608
    s_waitcnt vmcnt(8)
    ds_write_b128 v6, v[128:131] offset:0
    ds_write_b128 v6, v[132:135] offset:1024
    ds_write_b128 v6, v[136:139] offset:2048
    ds_write_b128 v6, v[140:143] offset:3072
    ds_read_b64_tr_b16 v[128:129], v15 offset:0
    ds_read_b64_tr_b16 v[130:131], v15 offset:512
    ds_read_b64_tr_b16 v[132:133], v15 offset:32
    ds_read_b64_tr_b16 v[134:135], v15 offset:544
    ds_read_b64_tr_b16 v[136:137], v15 offset:64
    ds_read_b64_tr_b16 v[138:139], v15 offset:576
    ds_read_b64_tr_b16 v[140:141], v15 offset:96
    ds_read_b64_tr_b16 v[142:143], v15 offset:608
    s_waitcnt vmcnt(4)
    ds_write_b128 v6, v[144:147] offset:0
    ds_write_b128 v6, v[148:151] offset:1024
    ds_write_b128 v6, v[152:155] offset:2048
    ds_write_b128 v6, v[156:159] offset:3072
    ds_read_b64_tr_b16 v[144:145], v15 offset:0
    ds_read_b64_tr_b16 v[146:147], v15 offset:512
    ds_read_b64_tr_b16 v[148:149], v15 offset:32
    ds_read_b64_tr_b16 v[150:151], v15 offset:544
    ds_read_b64_tr_b16 v[152:153], v15 offset:64
    ds_read_b64_tr_b16 v[154:155], v15 offset:576
    ds_read_b64_tr_b16 v[156:157], v15 offset:96
    ds_read_b64_tr_b16 v[158:159], v15 offset:608
    s_waitcnt vmcnt(0)
    ds_write_b128 v6, v[160:163] offset:0
    ds_write_b128 v6, v[164:167] offset:1024
    ds_write_b128 v6, v[168:171] offset:2048
    ds_write_b128 v6, v[172:175] offset:3072
    ds_read_b64_tr_b16 v[160:161], v15 offset:0
    ds_read_b64_tr_b16 v[162:163], v15 offset:512
    ds_read_b64_tr_b16 v[164:165], v15 offset:32
    ds_read_b64_tr_b16 v[166:167], v15 offset:544
    ds_read_b64_tr_b16 v[168:169], v15 offset:64
    ds_read_b64_tr_b16 v[170:171], v15 offset:576
    ds_read_b64_tr_b16 v[172:173], v15 offset:96
    ds_read_b64_tr_b16 v[174:175], v15 offset:608
    s_branch L_b_tail
L_b_r2:
    s_cmp_ge_u32 s80, 9
    s_cbranch_scc1 L_b_r3
    s_mul_i32 s4, s79, 448
    v_add_u32 v205, s4, v8
    s_movk_i32 s5, 1280
    s_lshl_b32 s4, s92, 5
    v_add_u32 v206, s4, v11
    v_min_u32 v204, 1727, v205
    v_mul_lo_u32 v204, v204, s5
    v_add_u32 v204, v204, v206
    buffer_load_dwordx4 v[48:51], v204, s[48:51], 0 offen offset:0 nt
    v_add_u32 v205, 32, v205
    v_min_u32 v204, 1727, v205
    v_mul_lo_u32 v204, v204, s5
    v_add_u32 v204, v204, v206
    buffer_load_dwordx4 v[52:55], v204, s[48:51], 0 offen offset:0 nt
    v_add_u32 v205, 32, v205
    v_min_u32 v204, 1727, v205
    v_mul_lo_u32 v204, v204, s5
    v_add_u32 v204, v204, v206
    buffer_load_dwordx4 v[56:59], v204, s[48:51], 0 offen offset:0 nt
    v_add_u32 v205, 32, v205
    v_min_u32 v204, 1727, v205
    v_mul_lo_u32 v204, v204, s5
    v_add_u32 v204, v204, v206
    buffer_load_dwordx4 v[60:63], v204, s[48:51], 0 offen offset:0 nt
    v_add_u32 v205, 32, v205
    v_min_u32 v204, 1727, v205
    v_mul_lo_u32 v204, v204, s5
    v_add_u32 v204, v204, v206
    buffer_load_dwordx4 v[64:67], v204, s[48:51], 0 offen offset:0 nt
    v_add_u32 v205, 32, v205
    v_min_u32 v204, 1727, v205
    v_mul_lo_u32 v204, v204, s5
    v_add_u32 v204, v204, v206
    buffer_load_dwordx4 v[68:71], v204, s[48:51], 0 offen offset:0 nt
    v_add_u32 v205, 32, v205
    v_min_u32 v204, 1727, v205
    v_mul_lo_u32 v204, v204, s5
    v_add_u32 v204, v204, v206
    buffer_load_dwordx4 v[72:75], v204, s[48:51], 0 offen offset:0 nt
    v_add_u32 v205, 32, v205
    v_min_u32 v204, 1727, v205
    v_mul_lo_u32 v204, v204, s5
    v_add_u32 v204, v204, v206
    buffer_load_dwordx4 v[76:79], v204, s[48:51], 0 offen offset:0 nt
    v_add_u32 v205, 32, v205
    v_min_u32 v204, 1727, v205
    v_mul_lo_u32 v204, v204, s5
    v_add_u32 v204, v204, v206
    buffer_load_dwordx4 v[80:83], v204, s[48:51], 0 offen offset:0 nt
    v_add_u32 v205, 32, v205
    v_min_u32 v204, 1727, v205
    v_mul_lo_u32 v204, v204, s5
    v_add_u32 v204, v204, v206
    buffer_load_dwordx4 v[84:87], v204, s[48:51], 0 offen offset:0 nt
    v_add_u32 v205, 32, v205
    v_min_u32 v204, 1727, v205
    v_mul_lo_u32 v204, v204, s5
    v_add_u32 v204, v204, v206
    buffer_load_dwordx4 v[88:91], v204, s[48:51], 0 offen offset:0 nt
    v_add_u32 v205, 32, v205
    v_min_u32 v204, 1727, v205
    v_mul_lo_u32 v204, v204, s5
    v_add_u32 v204, v204, v206
    buffer_load_dwordx4 v[92:95], v204, s[48:51], 0 offen offset:0 nt
    v_add_u32 v205, 32, v205
    v_min_u32 v204, 1727, v205
    v_mul_lo_u32 v204, v204, s5
    v_add_u32 v204, v204, v206
    buffer_load_dwordx4 v[96:99], v204, s[48:51], 0 offen offset:0 nt
    v_add_u32 v205, 32, v205
    v_min_u32 v204, 1727, v205
    v_mul_lo_u32 v204, v204, s5
    v_add_u32 v204, v204, v206
    buffer_load_dwordx4 v[100:103], v204, s[48:51], 0 offen offset:0 nt
    s_waitcnt vmcnt(13)
    ds_write_b128 v4, v[48:51]
    ds_read_b64_tr_b16 v[48:49], v5
    ds_read_b64_tr_b16 v[50:51], v5 offset:512
    s_waitcnt vmcnt(12)
    ds_write_b128 v4, v[52:55]
    ds_read_b64_tr_b16 v[52:53], v5
    ds_read_b64_tr_b16 v[54:55], v5 offset:512
    s_waitcnt vmcnt(11)
    ds_write_b128 v4, v[56:59]
    ds_read_b64_tr_b16 v[56:57], v5
    ds_read_b64_tr_b16 v[58:59], v5 offset:512
    s_waitcnt vmcnt(10)
    ds_write_b128 v4, v[60:63]
    ds_read_b64_tr_b16 v[60:61], v5
    ds_read_b64_tr_b16 v[62:63], v5 offset:512
    s_waitcnt vmcnt(9)
    ds_write_b128 v4, v[64:67]
    ds_read_b64_tr_b16 v[64:65], v5
    ds_read_b64_tr_b16 v[66:67], v5 offset:512
    s_waitcnt vmcnt(8)
    ds_write_b128 v4, v[68:71]
    ds_read_b64_tr_b16 v[68:69], v5
    ds_read_b64_tr_b16 v[70:71], v5 offset:512
    s_waitcnt vmcnt(7)
    ds_write_b128 v4, v[72:75]
    ds_read_b64_tr_b16 v[72:73], v5
    ds_read_b64_tr_b16 v[74:75], v5 offset:512
    s_waitcnt vmcnt(6)
    ds_write_b128 v4, v[76:79]
    ds_read_b64_tr_b16 v[76:77], v5
    ds_read_b64_tr_b16 v[78:79], v5 offset:512
    s_waitcnt vmcnt(5)
    ds_write_b128 v4, v[80:83]
    ds_read_b64_tr_b16 v[80:81], v5
    ds_read_b64_tr_b16 v[82:83], v5 offset:512
    s_waitcnt vmcnt(4)
    ds_write_b128 v4, v[84:87]
    ds_read_b64_tr_b16 v[84:85], v5
    ds_read_b64_tr_b16 v[86:87], v5 offset:512
    s_waitcnt vmcnt(3)
    ds_write_b128 v4, v[88:91]
    ds_read_b64_tr_b16 v[88:89], v5
    ds_read_b64_tr_b16 v[90:91], v5 offset:512
    s_waitcnt vmcnt(2)
    ds_write_b128 v4, v[92:95]
    ds_read_b64_tr_b16 v[92:93], v5
    ds_read_b64_tr_b16 v[94:95], v5 offset:512
    s_waitcnt vmcnt(1)
    ds_write_b128 v4, v[96:99]
    ds_read_b64_tr_b16 v[96:97], v5
    ds_read_b64_tr_b16 v[98:99], v5 offset:512
    s_waitcnt vmcnt(0)
    ds_write_b128 v4, v[100:103]
    ds_read_b64_tr_b16 v[100:101], v5
    ds_read_b64_tr_b16 v[102:103], v5 offset:512
    s_branch L_b_tail
L_b_r3:
    s_cmp_ge_u32 s80, 10
    s_cbranch_scc1 L_b_r4
    s_mul_i32 s4, s79, 160
    v_add_u32 v204, s4, v12
    s_movk_i32 s5, 3456
    v_mul_lo_u32 v204, v204, s5
    v_add_u32 v204, v204, v13
    s_lshl_b32 s4, s93, 6
    v_add_u32 v204, s4, v204
    buffer_load_dwordx4 v[104:107], v204, s[40:43], 0 offen offset:0 nt
    v_add_u32 v204, 13824, v204
    buffer_load_dwordx4 v[108:111], v204, s[40:43], 0 offen offset:0 nt
    v_add_u32 v204, 96768, v204
    buffer_load_dwordx4 v[112:115], v204, s[40:43], 0 offen offset:0 nt
    v_add_u32 v204, 13824, v204
    buffer_load_dwordx4 v[116:119], v204, s[40:43], 0 offen offset:0 nt
    v_add_u32 v204, 96768, v204
    buffer_load_dwordx4 v[120:123], v204, s[40:43], 0 offen offset:0 nt
    v_add_u32 v204, 13824, v204
    buffer_load_dwordx4 v[124:127], v204, s[40:43], 0 offen offset:0 nt
    v_add_u32 v204, 96768, v204
    buffer_load_dwordx4 v[128:131], v204, s[40:43], 0 offen offset:0 nt
    v_add_u32 v204, 13824, v204
    buffer_load_dwordx4 v[132:135], v204, s[40:43], 0 offen offset:0 nt
    v_add_u32 v204, 96768, v204
    buffer_load_dwordx4 v[136:139], v204, s[40:43], 0 offen offset:0 nt
    v_add_u32 v204, 13824, v204
    buffer_load_dwordx4 v[140:143], v204, s[40:43], 0 offen offset:0 nt
    s_mul_i32 s4, s79, 448
    v_add_u32 v205, s4, v8
    s_movk_i32 s5, 1280
    s_lshl_b32 s4, s92, 5
    v_add_u32 v206, s4, v11
    v_min_u32 v204, 1727, v205
    v_mul_lo_u32 v204, v204, s5
    v_add_u32 v204, v204, v206
    buffer_load_dwordx4 v[48:51], v204, s[48:51], 0 offen offset:0 nt
    v_add_u32 v205, 32, v205
    v_min_u32 v204, 1727, v205
    v_mul_lo_u32 v204, v204, s5
    v_add_u32 v204, v204, v206
    buffer_load_dwordx4 v[52:55], v204, s[48:51], 0 offen offset:0 nt
    v_add_u32 v205, 32, v205
    v_min_u32 v204, 1727, v205
    v_mul_lo_u32 v204, v204, s5
    v_add_u32 v204, v204, v206
    buffer_load_dwordx4 v[56:59], v204, s[48:51], 0 offen offset:0 nt
    v_add_u32 v205, 32, v205
    v_min_u32 v204, 1727, v205
    v_mul_lo_u32 v204, v204, s5
    v_add_u32 v204, v204, v206
    buffer_load_dwordx4 v[60:63], v204, s[48:51], 0 offen offset:0 nt
    v_add_u32 v205, 32, v205
    v_min_u32 v204, 1727, v205
    v_mul_lo_u32 v204, v204, s5
    v_add_u32 v204, v204, v206
    buffer_load_dwordx4 v[64:67], v204, s[48:51], 0 offen offset:0 nt
    v_add_u32 v205, 32, v205
    v_min_u32 v204, 1727, v205
    v_mul_lo_u32 v204, v204, s5
    v_add_u32 v204, v204, v206
    buffer_load_dwordx4 v[68:71], v204, s[48:51], 0 offen offset:0 nt
    v_add_u32 v205, 32, v205
    v_min_u32 v204, 1727, v205
    v_mul_lo_u32 v204, v204, s5
    v_add_u32 v204, v204, v206
    buffer_load_dwordx4 v[72:75], v204, s[48:51], 0 offen offset:0 nt
    v_add_u32 v205, 32, v205
    v_min_u32 v204, 1727, v205
    v_mul_lo_u32 v204, v204, s5
    v_add_u32 v204, v204, v206
    buffer_load_dwordx4 v[76:79], v204, s[48:51], 0 offen offset:0 nt
    v_add_u32 v205, 32, v205
    v_min_u32 v204, 1727, v205
    v_mul_lo_u32 v204, v204, s5
    v_add_u32 v204, v204, v206
    buffer_load_dwordx4 v[80:83], v204, s[48:51], 0 offen offset:0 nt
    v_add_u32 v205, 32, v205
    v_min_u32 v204, 1727, v205
    v_mul_lo_u32 v204, v204, s5
    v_add_u32 v204, v204, v206
    buffer_load_dwordx4 v[84:87], v204, s[48:51], 0 offen offset:0 nt
    v_add_u32 v205, 32, v205
    v_min_u32 v204, 1727, v205
    v_mul_lo_u32 v204, v204, s5
    v_add_u32 v204, v204, v206
    buffer_load_dwordx4 v[88:91], v204, s[48:51], 0 offen offset:0 nt
    v_add_u32 v205, 32, v205
    v_min_u32 v204, 1727, v205
    v_mul_lo_u32 v204, v204, s5
    v_add_u32 v204, v204, v206
    buffer_load_dwordx4 v[92:95], v204, s[48:51], 0 offen offset:0 nt
    v_add_u32 v205, 32, v205
    v_min_u32 v204, 1727, v205
    v_mul_lo_u32 v204, v204, s5
    v_add_u32 v204, v204, v206
    buffer_load_dwordx4 v[96:99], v204, s[48:51], 0 offen offset:0 nt
    v_add_u32 v205, 32, v205
    v_min_u32 v204, 1727, v205
    v_mul_lo_u32 v204, v204, s5
    v_add_u32 v204, v204, v206
    buffer_load_dwordx4 v[100:103], v204, s[48:51], 0 offen offset:0 nt
    s_waitcnt vmcnt(22)
    ds_write_b128 v6, v[104:107]
    ds_write_b128 v6, v[108:111] offset:1024
    ds_read_b64_tr_b16 v[104:105], v7
    ds_read_b64_tr_b16 v[106:107], v7 offset:1024
    ds_read_b64_tr_b16 v[108:109], v7 offset:32
    ds_read_b64_tr_b16 v[110:111], v7 offset:1056
    s_waitcnt vmcnt(20)
    ds_write_b128 v6, v[112:115]
    ds_write_b128 v6, v[116:119] offset:1024
    ds_read_b64_tr_b16 v[112:113], v7
    ds_read_b64_tr_b16 v[114:115], v7 offset:1024
    ds_read_b64_tr_b16 v[116:117], v7 offset:32
    ds_read_b64_tr_b16 v[118:119], v7 offset:1056
    s_waitcnt vmcnt(18)
    ds_write_b128 v6, v[120:123]
    ds_write_b128 v6, v[124:127] offset:1024
    ds_read_b64_tr_b16 v[120:121], v7
    ds_read_b64_tr_b16 v[122:123], v7 offset:1024
    ds_read_b64_tr_b16 v[124:125], v7 offset:32
    ds_read_b64_tr_b16 v[126:127], v7 offset:1056
    s_waitcnt vmcnt(16)
    ds_write_b128 v6, v[128:131]
    ds_write_b128 v6, v[132:135] offset:1024
    ds_read_b64_tr_b16 v[128:129], v7
    ds_read_b64_tr_b16 v[130:131], v7 offset:1024
    ds_read_b64_tr_b16 v[132:133], v7 offset:32
    ds_read_b64_tr_b16 v[134:135], v7 offset:1056
    s_waitcnt vmcnt(14)
    ds_write_b128 v6, v[136:139]
    ds_write_b128 v6, v[140:143] offset:1024
    ds_read_b64_tr_b16 v[136:137], v7
    ds_read_b64_tr_b16 v[138:139], v7 offset:1024
    ds_read_b64_tr_b16 v[140:141], v7 offset:32
    ds_read_b64_tr_b16 v[142:143], v7 offset:1056
    s_waitcnt vmcnt(13)
    ds_write_b128 v4, v[48:51]
    ds_read_b64_tr_b16 v[48:49], v5
    ds_read_b64_tr_b16 v[50:51], v5 offset:512
    s_waitcnt vmcnt(12)
    ds_write_b128 v4, v[52:55]
    ds_read_b64_tr_b16 v[52:53], v5
    ds_read_b64_tr_b16 v[54:55], v5 offset:512
    s_waitcnt vmcnt(11)
    ds_write_b128 v4, v[56:59]
    ds_read_b64_tr_b16 v[56:57], v5
    ds_read_b64_tr_b16 v[58:59], v5 offset:512
    s_waitcnt vmcnt(10)
    ds_write_b128 v4, v[60:63]
    ds_read_b64_tr_b16 v[60:61], v5
    ds_read_b64_tr_b16 v[62:63], v5 offset:512
    s_waitcnt vmcnt(9)
    ds_write_b128 v4, v[64:67]
    ds_read_b64_tr_b16 v[64:65], v5
    ds_read_b64_tr_b16 v[66:67], v5 offset:512
    s_waitcnt vmcnt(8)
    ds_write_b128 v4, v[68:71]
    ds_read_b64_tr_b16 v[68:69], v5
    ds_read_b64_tr_b16 v[70:71], v5 offset:512
    s_waitcnt vmcnt(7)
    ds_write_b128 v4, v[72:75]
    ds_read_b64_tr_b16 v[72:73], v5
    ds_read_b64_tr_b16 v[74:75], v5 offset:512
    s_waitcnt vmcnt(6)
    ds_write_b128 v4, v[76:79]
    ds_read_b64_tr_b16 v[76:77], v5
    ds_read_b64_tr_b16 v[78:79], v5 offset:512
    s_waitcnt vmcnt(5)
    ds_write_b128 v4, v[80:83]
    ds_read_b64_tr_b16 v[80:81], v5
    ds_read_b64_tr_b16 v[82:83], v5 offset:512
    s_waitcnt vmcnt(4)
    ds_write_b128 v4, v[84:87]
    ds_read_b64_tr_b16 v[84:85], v5
    ds_read_b64_tr_b16 v[86:87], v5 offset:512
    s_waitcnt vmcnt(3)
    ds_write_b128 v4, v[88:91]
    ds_read_b64_tr_b16 v[88:89], v5
    ds_read_b64_tr_b16 v[90:91], v5 offset:512
    s_waitcnt vmcnt(2)
    ds_write_b128 v4, v[92:95]
    ds_read_b64_tr_b16 v[92:93], v5
    ds_read_b64_tr_b16 v[94:95], v5 offset:512
    s_waitcnt vmcnt(1)
    ds_write_b128 v4, v[96:99]
    ds_read_b64_tr_b16 v[96:97], v5
    ds_read_b64_tr_b16 v[98:99], v5 offset:512
    s_waitcnt vmcnt(0)
    ds_write_b128 v4, v[100:103]
    ds_read_b64_tr_b16 v[100:101], v5
    ds_read_b64_tr_b16 v[102:103], v5 offset:512
    s_branch L_b_tail
L_b_r4:
    s_cmp_ge_u32 s80, 15
    s_cbranch_scc1 L_b_r5
    s_min_u32 s6, s93, 53
    s_mov_b32 s95, s93
    s_mov_b32 s93, s6
    v_min_u32 v208, 39, v0
    v_cmp_le_u32 vcc, 20, v208
    v_mov_b32 v209, 0
    v_mov_b32 v210, 1
    s_nop 0
    v_cndmask_b32 v209, v209, v210, vcc
    v_mul_u32_u24 v210, 20, v209
    v_sub_u32 v210, v208, v210
    v_lshlrev_b32 v210, 4, v210
    s_mul_i32 s4, s79, 320
    v_mul_u32_u24 v211, 1280, v209
    v_add3_u32 v211, v211, v210, s4
    buffer_load_dwordx4 v[184:187], v211, s[56:59], 0 offen offset:0
    v_mul_u32_u24 v211, 336, v209
    v_add_u32 v211, v211, v210
    s_mul_i32 s4, s79, 672
    s_add_u32 s4, s4, 88576
    v_add_u32 v211, s4, v211
    s_mul_i32 s6, s79, 160
    s_lshl_b32 s7, s94, 7
    s_add_u32 s7, s7, 2560
    v_lshrrev_b32 v204, 3, v0
    v_add_u32 v204, s6, v204
    s_movk_i32 s5, 7680
    v_mul_lo_u32 v204, v204, s5
    v_and_b32 v205, 7, v0
    v_lshl_add_u32 v204, v205, 4, v204
    v_add_u32 v204, s7, v204
    buffer_load_dwordx4 v[48:51], v204, s[60:63], 0 offen offset:0 nt
    v_add_u32 v204, 61440, v204
    buffer_load_dwordx4 v[52:55], v204, s[60:63], 0 offen offset:0 nt
    v_add_u32 v204, 61440, v204
    buffer_load_dwordx4 v[56:59], v204, s[60:63], 0 offen offset:0 nt
    v_add_u32 v204, 61440, v204
    buffer_load_dwordx4 v[60:63], v204, s[60:63], 0 offen offset:0 nt
    v_add_u32 v204, 61440, v204
    buffer_load_dwordx4 v[64:67], v204, s[60:63], 0 offen offset:0 nt
    v_add_u32 v204, 61440, v204
    buffer_load_dwordx4 v[68:71], v204, s[60:63], 0 offen offset:0 nt
    v_add_u32 v204, 61440, v204
    buffer_load_dwordx4 v[72:75], v204, s[60:63], 0 offen offset:0 nt
    v_add_u32 v204, 61440, v204
    buffer_load_dwordx4 v[76:79], v204, s[60:63], 0 offen offset:0 nt
    v_add_u32 v204, 61440, v204
    buffer_load_dwordx4 v[80:83], v204, s[60:63], 0 offen offset:0 nt
    v_add_u32 v204, 61440, v204
    buffer_load_dwordx4 v[84:87], v204, s[60:63], 0 offen offset:0 nt
    v_add_u32 v204, 61440, v204
    buffer_load_dwordx4 v[88:91], v204, s[60:63], 0 offen offset:0 nt
    v_add_u32 v204, 61440, v204
    buffer_load_dwordx4 v[92:95], v204, s[60:63], 0 offen offset:0 nt
    v_add_u32 v204, 61440, v204
    buffer_load_dwordx4 v[144:147], v204, s[60:63], 0 offen offset:0 nt
    v_add_u32 v204, 61440, v204
    buffer_load_dwordx4 v[148:151], v204, s[60:63], 0 offen offset:0 nt
    v_add_u32 v204, 61440, v204
    buffer_load_dwordx4 v[152:155], v204, s[60:63], 0 offen offset:0 nt
    v_add_u32 v204, 61440, v204
    buffer_load_dwordx4 v[156:159], v204, s[60:63], 0 offen offset:0 nt
    v_add_u32 v204, 61440, v204
    buffer_load_dwordx4 v[160:163], v204, s[60:63], 0 offen offset:0 nt
    v_add_u32 v204, 61440, v204
    buffer_load_dwordx4 v[164:167], v204, s[60:63], 0 offen offset:0 nt
    v_add_u32 v204, 61440, v204
    buffer_load_dwordx4 v[168:171], v204, s[60:63], 0 offen offset:0 nt
    v_add_u32 v204, 61440, v204
    buffer_load_dwordx4 v[172:175], v204, s[60:63], 0 offen offset:0 nt
    s_mul_i32 s4, s79, 160
    v_add_u32 v204, s4, v12
    s_movk_i32 s5, 3456
    v_mul_lo_u32 v204, v204, s5
    v_add_u32 v204, v204, v13
    s_lshl_b32 s4, s93, 6
    v_add_u32 v204, s4, v204
    buffer_load_dwordx4 v[104:107], v204, s[40:43], 0 offen offset:0 nt
    v_add_u32 v204, 13824, v204
    buffer_load_dwordx4 v[108:111], v204, s[40:43], 0 offen offset:0 nt
    v_add_u32 v204, 96768, v204
    buffer_load_dwordx4 v[112:115], v204, s[40:43], 0 offen offset:0 nt
    v_add_u32 v204, 13824, v204
    buffer_load_dwordx4 v[116:119], v204, s[40:43], 0 offen offset:0 nt
    v_add_u32 v204, 96768, v204
    buffer_load_dwordx4 v[120:123], v204, s[40:43], 0 offen offset:0 nt
    v_add_u32 v204, 13824, v204
    buffer_load_dwordx4 v[124:127], v204, s[40:43], 0 offen offset:0 nt
    v_add_u32 v204, 96768, v204
    buffer_load_dwordx4 v[128:131], v204, s[40:43], 0 offen offset:0 nt
    v_add_u32 v204, 13824, v204
    buffer_load_dwordx4 v[132:135], v204, s[40:43], 0 offen offset:0 nt
    v_add_u32 v204, 96768, v204
    buffer_load_dwordx4 v[136:139], v204, s[40:43], 0 offen offset:0 nt
    v_add_u32 v204, 13824, v204
    buffer_load_dwordx4 v[140:143], v204, s[40:43], 0 offen offset:0 nt
    s_mov_b32 s93, s95
    s_waitcnt vmcnt(26)
    ds_write_b128 v6, v[48:51] offset:0
    ds_write_b128 v6, v[52:55] offset:1024
    ds_write_b128 v6, v[56:59] offset:2048
    ds_write_b128 v6, v[60:63] offset:3072
    ds_read_b64_tr_b16 v[48:49], v15 offset:0
    ds_read_b64_tr_b16 v[50:51], v15 offset:512
    ds_read_b64_tr_b16 v[52:53], v15 offset:32
    ds_read_b64_tr_b16 v[54:55], v15 offset:544
    ds_read_b64_tr_b16 v[56:57], v15 offset:64
    ds_read_b64_tr_b16 v[58:59], v15 offset:576
    ds_read_b64_tr_b16 v[60:61], v15 offset:96
    ds_read_b64_tr_b16 v[62:63], v15 offset:608
    s_waitcnt vmcnt(22)
    ds_write_b128 v6, v[64:67] offset:0
    ds_write_b128 v6, v[68:71] offset:1024
    ds_write_b128 v6, v[72:75] offset:2048
    ds_write_b128 v6, v[76:79] offset:3072
    ds_read_b64_tr_b16 v[64:65], v15 offset:0
    ds_read_b64_tr_b16 v[66:67], v15 offset:512
    ds_read_b64_tr_b16 v[68:69], v15 offset:32
    ds_read_b64_tr_b16 v[70:71], v15 offset:544
    ds_read_b64_tr_b16 v[72:73], v15 offset:64
    ds_read_b64_tr_b16 v[74:75], v15 offset:576
    ds_read_b64_tr_b16 v[76:77], v15 offset:96
    ds_read_b64_tr_b16 v[78:79], v15 offset:608
    s_waitcnt vmcnt(18)
    ds_write_b128 v6, v[80:83] offset:0
    ds_write_b128 v6, v[84:87] offset:1024
    ds_write_b128 v6, v[88:91] offset:2048
    ds_write_b128 v6, v[92:95] offset:3072
    ds_read_b64_tr_b16 v[80:81], v15 offset:0
    ds_read_b64_tr_b16 v[82:83], v15 offset:512
    ds_read_b64_tr_b16 v[84:85], v15 offset:32
    ds_read_b64_tr_b16 v[86:87], v15 offset:544
    ds_read_b64_tr_b16 v[88:89], v15 offset:64
    ds_read_b64_tr_b16 v[90:91], v15 offset:576
    ds_read_b64_tr_b16 v[92:93], v15 offset:96
    ds_read_b64_tr_b16 v[94:95], v15 offset:608
    s_waitcnt vmcnt(14)
    ds_write_b128 v6, v[144:147] offset:0
    ds_write_b128 v6, v[148:151] offset:1024
    ds_write_b128 v6, v[152:155] offset:2048
    ds_write_b128 v6, v[156:159] offset:3072
    ds_read_b64_tr_b16 v[144:145], v15 offset:0
    ds_read_b64_tr_b16 v[146:147], v15 offset:512
    ds_read_b64_tr_b16 v[148:149], v15 offset:32
    ds_read_b64_tr_b16 v[150:151], v15 offset:544
    ds_read_b64_tr_b16 v[152:153], v15 offset:64
    ds_read_b64_tr_b16 v[154:155], v15 offset:576
    ds_read_b64_tr_b16 v[156:157], v15 offset:96
    ds_read_b64_tr_b16 v[158:159], v15 offset:608
    s_waitcnt vmcnt(10)
    ds_write_b128 v6, v[160:163] offset:0
    ds_write_b128 v6, v[164:167] offset:1024
    ds_write_b128 v6, v[168:171] offset:2048
    ds_write_b128 v6, v[172:175] offset:3072
    ds_read_b64_tr_b16 v[160:161], v15 offset:0
    ds_read_b64_tr_b16 v[162:163], v15 offset:512
    ds_read_b64_tr_b16 v[164:165], v15 offset:32
    ds_read_b64_tr_b16 v[166:167], v15 offset:544
    ds_read_b64_tr_b16 v[168:169], v15 offset:64
    ds_read_b64_tr_b16 v[170:171], v15 offset:576
    ds_read_b64_tr_b16 v[172:173], v15 offset:96
    ds_read_b64_tr_b16 v[174:175], v15 offset:608
    v_lshlrev_b32 v216, 16, v184
    v_and_b32 v217, 0xffff0000, v184
    v_lshlrev_b32 v218, 16, v185
    v_and_b32 v219, 0xffff0000, v185
    v_lshlrev_b32 v220, 16, v186
    v_and_b32 v221, 0xffff0000, v186
    v_lshlrev_b32 v222, 16, v187
    v_and_b32 v223, 0xffff0000, v187
    v_mul_f32 v224, 0xbfb8aa3b, v216
    v_mul_f32 v225, 0xbfb8aa3b, v217
    v_mul_f32 v226, 0xbfb8aa3b, v218
    v_mul_f32 v227, 0xbfb8aa3b, v219
    v_mul_f32 v228, 0xbfb8aa3b, v220
    v_mul_f32 v229, 0xbfb8aa3b, v221
    v_mul_f32 v230, 0xbfb8aa3b, v222
    v_mul_f32 v231, 0xbfb8aa3b, v223
    v_exp_f32 v224, v224
    v_exp_f32 v225, v225
    v_exp_f32 v226, v226
    v_exp_f32 v227, v227
    v_exp_f32 v228, v228
    v_exp_f32 v229, v229
    v_exp_f32 v230, v230
    v_exp_f32 v231, v231
    s_nop 0
    v_add_f32 v224, 1.0, v224
    v_add_f32 v225, 1.0, v225
    v_add_f32 v226, 1.0, v226
    v_add_f32 v227, 1.0, v227
    v_add_f32 v228, 1.0, v228
    v_add_f32 v229, 1.0, v229
    v_add_f32 v230, 1.0, v230
    v_add_f32 v231, 1.0, v231
    v_rcp_f32 v224, v224
    v_rcp_f32 v225, v225
    v_rcp_f32 v226, v226
    v_rcp_f32 v227, v227
    v_rcp_f32 v228, v228
    v_rcp_f32 v229, v229
    v_rcp_f32 v230, v230
    v_rcp_f32 v231, v231
    s_nop 0
    v_mul_f32 v216, v216, v224
    v_mul_f32 v217, v217, v225
    v_mul_f32 v218, v218, v226
    v_mul_f32 v219, v219, v227
    v_mul_f32 v220, v220, v228
    v_mul_f32 v221, v221, v229
    v_mul_f32 v222, v222, v230
    v_mul_f32 v223, v223, v231
    v_cvt_pk_bf16_f32 v184, v216, v217
    v_cvt_pk_bf16_f32 v185, v218, v219
    v_cvt_pk_bf16_f32 v186, v220, v221
    v_cvt_pk_bf16_f32 v187, v222, v223
    ds_write_b128 v211, v[184:187]
    v_and_b32 v208, 1, v1
    v_mul_u32_u24 v208, 336, v208
    v_lshl_add_u32 v208, v2, 4, v208
    s_mul_i32 s4, s79, 672
    s_add_u32 s4, s4, 88576
    v_add_u32 v208, s4, v208
    ds_read_b128 v[216:219], v208 offset:0
    ds_read_b128 v[220:223], v208 offset:64
    ds_read_b128 v[224:227], v208 offset:128
    ds_read_b128 v[228:231], v208 offset:192
    ds_read_b128 v[232:235], v208 offset:256
    s_waitcnt lgkmcnt(0)
    v_mfma_f32_16x16x32_bf16 v[236:239], v[48:51], v[216:219], 0
    v_mfma_f32_16x16x32_bf16 v[240:243], v[52:55], v[216:219], 0
    v_mfma_f32_16x16x32_bf16 v[244:247], v[56:59], v[216:219], 0
    v_mfma_f32_16x16x32_bf16 v[248:251], v[60:63], v[216:219], 0
    v_mfma_f32_16x16x32_bf16 v[236:239], v[64:67], v[220:223], v[236:239]
    v_mfma_f32_16x16x32_bf16 v[240:243], v[68:71], v[220:223], v[240:243]
    v_mfma_f32_16x16x32_bf16 v[244:247], v[72:75], v[220:223], v[244:247]
    v_mfma_f32_16x16x32_bf16 v[248:251], v[76:79], v[220:223], v[248:251]
    v_mfma_f32_16x16x32_bf16 v[236:239], v[80:83], v[224:227], v[236:239]
    v_mfma_f32_16x16x32_bf16 v[240:243], v[84:87], v[224:227], v[240:243]
    v_mfma_f32_16x16x32_bf16 v[244:247], v[88:91], v[224:227], v[244:247]
    v_mfma_f32_16x16x32_bf16 v[248:251], v[92:95], v[224:227], v[248:251]
    v_mfma_f32_16x16x32_bf16 v[236:239], v[144:147], v[228:231], v[236:239]
    v_mfma_f32_16x16x32_bf16 v[240:243], v[148:151], v[228:231], v[240:243]
    v_mfma_f32_16x16x32_bf16 v[244:247], v[152:155], v[228:231], v[244:247]
    v_mfma_f32_16x16x32_bf16 v[248:251], v[156:159], v[228:231], v[248:251]
    v_mfma_f32_16x16x32_bf16 v[236:239], v[160:163], v[232:235], v[236:239]
    v_mfma_f32_16x16x32_bf16 v[240:243], v[164:167], v[232:235], v[240:243]
    v_mfma_f32_16x16x32_bf16 v[244:247], v[168:171], v[232:235], v[244:247]
    v_mfma_f32_16x16x32_bf16 v[248:251], v[172:175], v[232:235], v[248:251]
    s_nop 7
    s_nop 1
    v_lshl_add_u32 v208, v2, 1, v1
    v_lshlrev_b32 v208, 4, v208
    s_lshl_b32 s4, s79, 9
    s_add_u32 s4, s4, 86016
    v_add_u32 v208, s4, v208
    s_mov_b32 exec_lo, 0x30003
    s_mov_b32 exec_hi, 0x30003
    ds_write_b128 v208, v[236:239] offset:0
    ds_write_b128 v208, v[240:243] offset:128
    ds_write_b128 v208, v[244:247] offset:256
    ds_write_b128 v208, v[248:251] offset:384
    s_mov_b64 exec, 1
    v_mov_b32 v209, 158988
    v_mov_b32 v210, 1
    ds_add_rtn_u32 v210, v209, v210
    s_waitcnt lgkmcnt(0)
    v_readfirstlane_b32 s4, v210
    s_mov_b64 exec, -1
    s_nop 2
    s_cmp_lg_u32 s4, 3
    s_cbranch_scc1 L_p0n_done_25
    s_mov_b64 exec, 0xffffffff
    v_lshlrev_b32 v232, 4, v0
    v_add_u32 v232, 86016, v232
    ds_read_b128 v[216:219], v232 offset:0
    ds_read_b128 v[220:223], v232 offset:512
    ds_read_b128 v[224:227], v232 offset:1024
    ds_read_b128 v[228:231], v232 offset:1536
    s_waitcnt lgkmcnt(0)
    v_add_f32 v216, v216, v220
    v_add_f32 v224, v224, v228
    v_add_f32 v217, v217, v221
    v_add_f32 v225, v225, v229
    v_add_f32 v218, v218, v222
    v_add_f32 v226, v226, v230
    v_add_f32 v219, v219, v223
    v_add_f32 v227, v227, v231
    v_add_f32 v216, v216, v224
    v_add_f32 v217, v217, v225
    v_add_f32 v218, v218, v226
    v_add_f32 v219, v219, v227
    v_mul_u32_u24 v208, 10240, v10
    v_lshrrev_b32 v209, 1, v0
    v_lshl_add_u32 v208, v209, 4, v208
    s_lshl_b32 s4, s94, 8
    s_add_u32 s4, s4, 376832
    v_add_u32 v208, s4, v208
    v_or_b32 v216, 1, v216
    buffer_store_dwordx4 v[216:219], v208, s[72:75], 0 offen offset:0 sc1
    s_mov_b64 exec, -1
L_p0n_done_25:
    s_waitcnt vmcnt(8)
    ds_write_b128 v6, v[104:107]
    ds_write_b128 v6, v[108:111] offset:1024
    ds_read_b64_tr_b16 v[104:105], v7
    ds_read_b64_tr_b16 v[106:107], v7 offset:1024
    ds_read_b64_tr_b16 v[108:109], v7 offset:32
    ds_read_b64_tr_b16 v[110:111], v7 offset:1056
    s_waitcnt vmcnt(6)
    ds_write_b128 v6, v[112:115]
    ds_write_b128 v6, v[116:119] offset:1024
    ds_read_b64_tr_b16 v[112:113], v7
    ds_read_b64_tr_b16 v[114:115], v7 offset:1024
    ds_read_b64_tr_b16 v[116:117], v7 offset:32
    ds_read_b64_tr_b16 v[118:119], v7 offset:1056
    s_waitcnt vmcnt(4)
    ds_write_b128 v6, v[120:123]
    ds_write_b128 v6, v[124:127] offset:1024
    ds_read_b64_tr_b16 v[120:121], v7
    ds_read_b64_tr_b16 v[122:123], v7 offset:1024
    ds_read_b64_tr_b16 v[124:125], v7 offset:32
    ds_read_b64_tr_b16 v[126:127], v7 offset:1056
    s_waitcnt vmcnt(2)
    ds_write_b128 v6, v[128:131]
    ds_write_b128 v6, v[132:135] offset:1024
    ds_read_b64_tr_b16 v[128:129], v7
    ds_read_b64_tr_b16 v[130:131], v7 offset:1024
    ds_read_b64_tr_b16 v[132:133], v7 offset:32
    ds_read_b64_tr_b16 v[134:135], v7 offset:1056
    s_waitcnt vmcnt(0)
    ds_write_b128 v6, v[136:139]
    ds_write_b128 v6, v[140:143] offset:1024
    ds_read_b64_tr_b16 v[136:137], v7
    ds_read_b64_tr_b16 v[138:139], v7 offset:1024
    ds_read_b64_tr_b16 v[140:141], v7 offset:32
    ds_read_b64_tr_b16 v[142:143], v7 offset:1056
    s_branch L_b_tail
L_b_r5:
    s_min_u32 s6, s93, 53
    s_mov_b32 s95, s93
    s_mov_b32 s93, s6
    s_mul_i32 s4, s79, 160
    v_add_u32 v204, s4, v12
    s_movk_i32 s5, 3456
    v_mul_lo_u32 v204, v204, s5
    v_add_u32 v204, v204, v13
    s_lshl_b32 s4, s93, 6
    v_add_u32 v204, s4, v204
    buffer_load_dwordx4 v[104:107], v204, s[40:43], 0 offen offset:0 nt
    v_add_u32 v204, 13824, v204
    buffer_load_dwordx4 v[108:111], v204, s[40:43], 0 offen offset:0 nt
    v_add_u32 v204, 96768, v204
    buffer_load_dwordx4 v[112:115], v204, s[40:43], 0 offen offset:0 nt
    v_add_u32 v204, 13824, v204
    buffer_load_dwordx4 v[116:119], v204, s[40:43], 0 offen offset:0 nt
    v_add_u32 v204, 96768, v204
    buffer_load_dwordx4 v[120:123], v204, s[40:43], 0 offen offset:0 nt
    v_add_u32 v204, 13824, v204
    buffer_load_dwordx4 v[124:127], v204, s[40:43], 0 offen offset:0 nt
    v_add_u32 v204, 96768, v204
    buffer_load_dwordx4 v[128:131], v204, s[40:43], 0 offen offset:0 nt
    v_add_u32 v204, 13824, v204
    buffer_load_dwordx4 v[132:135], v204, s[40:43], 0 offen offset:0 nt
    v_add_u32 v204, 96768, v204
    buffer_load_dwordx4 v[136:139], v204, s[40:43], 0 offen offset:0 nt
    v_add_u32 v204, 13824, v204
    buffer_load_dwordx4 v[140:143], v204, s[40:43], 0 offen offset:0 nt
    s_mov_b32 s93, s95
    s_waitcnt vmcnt(8)
    ds_write_b128 v6, v[104:107]
    ds_write_b128 v6, v[108:111] offset:1024
    ds_read_b64_tr_b16 v[104:105], v7
    ds_read_b64_tr_b16 v[106:107], v7 offset:1024
    ds_read_b64_tr_b16 v[108:109], v7 offset:32
    ds_read_b64_tr_b16 v[110:111], v7 offset:1056
    s_waitcnt vmcnt(6)
    ds_write_b128 v6, v[112:115]
    ds_write_b128 v6, v[116:119] offset:1024
    ds_read_b64_tr_b16 v[112:113], v7
    ds_read_b64_tr_b16 v[114:115], v7 offset:1024
    ds_read_b64_tr_b16 v[116:117], v7 offset:32
    ds_read_b64_tr_b16 v[118:119], v7 offset:1056
    s_waitcnt vmcnt(4)
    ds_write_b128 v6, v[120:123]
    ds_write_b128 v6, v[124:127] offset:1024
    ds_read_b64_tr_b16 v[120:121], v7
    ds_read_b64_tr_b16 v[122:123], v7 offset:1024
    ds_read_b64_tr_b16 v[124:125], v7 offset:32
    ds_read_b64_tr_b16 v[126:127], v7 offset:1056
    s_waitcnt vmcnt(2)
    ds_write_b128 v6, v[128:131]
    ds_write_b128 v6, v[132:135] offset:1024
    ds_read_b64_tr_b16 v[128:129], v7
    ds_read_b64_tr_b16 v[130:131], v7 offset:1024
    ds_read_b64_tr_b16 v[132:133], v7 offset:32
    ds_read_b64_tr_b16 v[134:135], v7 offset:1056
    s_waitcnt vmcnt(0)
    ds_write_b128 v6, v[136:139]
    ds_write_b128 v6, v[140:143] offset:1024
    ds_read_b64_tr_b16 v[136:137], v7
    ds_read_b64_tr_b16 v[138:139], v7 offset:1024
    ds_read_b64_tr_b16 v[140:141], v7 offset:32
    ds_read_b64_tr_b16 v[142:143], v7 offset:1056
    s_branch L_b_tail
L_b_tail:
    s_cmp_ge_u32 s80, 5
    s_cbranch_scc1 L_t_not5
    s_lshr_b32 s94, s91, 2
    s_and_b32 s93, s91, 3
    v_and_b32 v184, 31, v0
    v_lshrrev_b32 v185, 1, v184
    v_mul_u32_u24 v186, 10240, v10
    v_lshl_add_u32 v186, v185, 4, v186
    s_lshl_b32 s4, s94, 8
    s_add_u32 s5, s4, 376832
    v_add_u32 v186, s5, v186
    v_mul_u32_u24 v187, 1280, v10
    v_lshl_add_u32 v187, v185, 3, v187
    s_lshl_b32 s5, s94, 7
    v_add_u32 v187, s5, v187
    buffer_load_dwordx2 v[188:189], v187, s[16:19], 0 offen offset:0
    s_mul_i32 s5, s93, 10
    s_add_u32 s5, s5, s94
    s_lshl_b32 s5, s5, 9
    s_add_u32 s5, s5, 344064
    v_lshlrev_b32 v190, 4, v184
    v_add_u32 v190, s5, v190
L_ga:
    buffer_load_dwordx4 v[192:195], v186, s[72:75], 0 offen offset:0 sc1
    s_waitcnt vmcnt(0)
    v_and_b32 v191, 1, v192
    v_cmp_eq_u32 vcc, 0, v191
    s_cbranch_vccz L_ga_done
    s_add_u32 s87, s87, 1
    s_cmp_lt_u32 s87, 400000
    s_cbranch_scc1 L_ga
    s_branch L_bail
L_ga_done:
    s_cmp_eq_u32 s93, 0
    s_cselect_b32 s8, 1.0, 0
    v_lshlrev_b32 v196, 16, v188
    v_and_b32 v197, 0xffff0000, v188
    v_lshlrev_b32 v198, 16, v189
    v_and_b32 v199, 0xffff0000, v189
    v_mul_f32 v196, s8, v196
    v_mul_f32 v197, s8, v197
    v_mul_f32 v198, s8, v198
    v_mul_f32 v199, s8, v199
    v_bfe_u32 v191, v1, 1, 2
    v_lshlrev_b32 v191, 14, v191
    v_and_b32 v248, 1, v1
    v_lshl_add_u32 v191, v248, 6, v191
    v_lshl_add_u32 v191, v2, 4, v191
    s_lshl_b32 s4, s93, 3
    s_lshl_b32 s5, s79, 1
    s_add_u32 s4, s4, s5
    s_lshl_b32 s4, s4, 9
    s_add_u32 s4, s4, 212992
    v_add_u32 v191, s4, v191
    v_mov_b32 v248, 212984
    s_mov_b64 exec, 0x1
L_lp_26:
    buffer_load_dwordx2 v[200:201], v248, s[72:75], 0 offen offset:0 sc1
    s_waitcnt vmcnt(0)
    v_cmp_eq_u32 vcc, 0, v201
    s_cbranch_vccz L_lp_done_27
    s_sleep 1
    s_add_u32 s87, s87, 1
    s_cmp_lt_u32 s87, 400000
    s_cbranch_scc1 L_lp_26
    s_branch L_bail
L_lp_done_27:
    s_mov_b64 exec, -1
    s_mov_b32 s96, 255
L_gp_28:
    s_bitcmp1_b32 s96, 0
    s_cbranch_scc0 L_gs__30
    buffer_load_dwordx4 v[200:203], v191, s[72:75], 0 offen offset:0 sc1
L_gs__30:
    s_bitcmp1_b32 s96, 1
    s_cbranch_scc0 L_gs__31
    buffer_load_dwordx4 v[204:207], v191, s[72:75], 0 offen offset:128 sc1
L_gs__31:
    s_bitcmp1_b32 s96, 2
    s_cbranch_scc0 L_gs__32
    buffer_load_dwordx4 v[208:211], v191, s[72:75], 0 offen offset:256 sc1
L_gs__32:
    s_bitcmp1_b32 s96, 3
    s_cbranch_scc0 L_gs__33
    buffer_load_dwordx4 v[212:215], v191, s[72:75], 0 offen offset:384 sc1
L_gs__33:
    s_bitcmp1_b32 s96, 4
    s_cbranch_scc0 L_gs__34
    buffer_load_dwordx4 v[216:219], v191, s[72:75], 0 offen offset:512 sc1
L_gs__34:
    s_bitcmp1_b32 s96, 5
    s_cbranch_scc0 L_gs__35
    buffer_load_dwordx4 v[220:223], v191, s[72:75], 0 offen offset:640 sc1
L_gs__35:
    s_bitcmp1_b32 s96, 6
    s_cbranch_scc0 L_gs__36
    buffer_load_dwordx4 v[224:227], v191, s[72:75], 0 offen offset:768 sc1
L_gs__36:
    s_bitcmp1_b32 s96, 7
    s_cbranch_scc0 L_gs__37
    buffer_load_dwordx4 v[228:231], v191, s[72:75], 0 offen offset:896 sc1
L_gs__37:
    s_waitcnt vmcnt(0)
    s_bitcmp1_b32 s96, 0
    s_cbranch_scc0 L_gc__38
    v_and_b32 v248, v200, v202
    v_and_b32 v248, 1, v248
    v_cmp_eq_u32 vcc, 0, v248
    s_cbranch_vccnz L_gc__38
    s_bitset0_b32 s96, 0
L_gc__38:
    s_bitcmp1_b32 s96, 1
    s_cbranch_scc0 L_gc__39
    v_and_b32 v248, v204, v206
    v_and_b32 v248, 1, v248
    v_cmp_eq_u32 vcc, 0, v248
    s_cbranch_vccnz L_gc__39
    s_bitset0_b32 s96, 1
L_gc__39:
    s_bitcmp1_b32 s96, 2
    s_cbranch_scc0 L_gc__40
    v_and_b32 v248, v208, v210
    v_and_b32 v248, 1, v248
    v_cmp_eq_u32 vcc, 0, v248
    s_cbranch_vccnz L_gc__40
    s_bitset0_b32 s96, 2
L_gc__40:
    s_bitcmp1_b32 s96, 3
    s_cbranch_scc0 L_gc__41
    v_and_b32 v248, v212, v214
    v_and_b32 v248, 1, v248
    v_cmp_eq_u32 vcc, 0, v248
    s_cbranch_vccnz L_gc__41
    s_bitset0_b32 s96, 3
L_gc__41:
    s_bitcmp1_b32 s96, 4
    s_cbranch_scc0 L_gc__42
    v_and_b32 v248, v216, v218
    v_and_b32 v248, 1, v248
    v_cmp_eq_u32 vcc, 0, v248
    s_cbranch_vccnz L_gc__42
    s_bitset0_b32 s96, 4
L_gc__42:
    s_bitcmp1_b32 s96, 5
    s_cbranch_scc0 L_gc__43
    v_and_b32 v248, v220, v222
    v_and_b32 v248, 1, v248
    v_cmp_eq_u32 vcc, 0, v248
    s_cbranch_vccnz L_gc__43
    s_bitset0_b32 s96, 5
L_gc__43:
    s_bitcmp1_b32 s96, 6
    s_cbranch_scc0 L_gc__44
    v_and_b32 v248, v224, v226
    v_and_b32 v248, 1, v248
    v_cmp_eq_u32 vcc, 0, v248
    s_cbranch_vccnz L_gc__44
    s_bitset0_b32 s96, 6
L_gc__44:
    s_bitcmp1_b32 s96, 7
    s_cbranch_scc0 L_gc__45
    v_and_b32 v248, v228, v230
    v_and_b32 v248, 1, v248
    v_cmp_eq_u32 vcc, 0, v248
    s_cbranch_vccnz L_gc__45
    s_bitset0_b32 s96, 7
L_gc__45:
    s_cmp_eq_u32 s96, 0
    s_cbranch_scc1 L_gp_done_29
    s_add_u32 s87, s87, 1
    s_cmp_lt_u32 s87, 400000
    s_cbranch_scc1 L_gp_28
    s_branch L_bail
L_gp_done_29:
    v_mfma_f32_16x16x32_bf16 v[232:235], v[48:51], v[200:203], 0
    v_mfma_f32_16x16x32_bf16 v[236:239], v[52:55], v[200:203], 0
    v_mfma_f32_16x16x32_bf16 v[240:243], v[56:59], v[200:203], 0
    v_mfma_f32_16x16x32_bf16 v[244:247], v[60:63], v[200:203], 0
    v_mfma_f32_16x16x32_bf16 v[232:235], v[64:67], v[204:207], v[232:235]
    v_mfma_f32_16x16x32_bf16 v[236:239], v[68:71], v[204:207], v[236:239]
    v_mfma_f32_16x16x32_bf16 v[240:243], v[72:75], v[204:207], v[240:243]
    v_mfma_f32_16x16x32_bf16 v[244:247], v[76:79], v[204:207], v[244:247]
    v_mfma_f32_16x16x32_bf16 v[232:235], v[80:83], v[208:211], v[232:235]
    v_mfma_f32_16x16x32_bf16 v[236:239], v[84:87], v[208:211], v[236:239]
    v_mfma_f32_16x16x32_bf16 v[240:243], v[88:91], v[208:211], v[240:243]
    v_mfma_f32_16x16x32_bf16 v[244:247], v[92:95], v[208:211], v[244:247]
    v_mfma_f32_16x16x32_bf16 v[232:235], v[96:99], v[212:215], v[232:235]
    v_mfma_f32_16x16x32_bf16 v[236:239], v[100:103], v[212:215], v[236:239]
    v_mfma_f32_16x16x32_bf16 v[240:243], v[104:107], v[212:215], v[240:243]
    v_mfma_f32_16x16x32_bf16 v[244:247], v[108:111], v[212:215], v[244:247]
    v_mfma_f32_16x16x32_bf16 v[232:235], v[112:115], v[216:219], v[232:235]
    v_mfma_f32_16x16x32_bf16 v[236:239], v[116:119], v[216:219], v[236:239]
    v_mfma_f32_16x16x32_bf16 v[240:243], v[120:123], v[216:219], v[240:243]
    v_mfma_f32_16x16x32_bf16 v[244:247], v[124:127], v[216:219], v[244:247]
    v_mfma_f32_16x16x32_bf16 v[232:235], v[128:131], v[220:223], v[232:235]
    v_mfma_f32_16x16x32_bf16 v[236:239], v[132:135], v[220:223], v[236:239]
    v_mfma_f32_16x16x32_bf16 v[240:243], v[136:139], v[220:223], v[240:243]
    v_mfma_f32_16x16x32_bf16 v[244:247], v[140:143], v[220:223], v[244:247]
    v_mfma_f32_16x16x32_bf16 v[232:235], v[144:147], v[224:227], v[232:235]
    v_mfma_f32_16x16x32_bf16 v[236:239], v[148:151], v[224:227], v[236:239]
    v_mfma_f32_16x16x32_bf16 v[240:243], v[152:155], v[224:227], v[240:243]
    v_mfma_f32_16x16x32_bf16 v[244:247], v[156:159], v[224:227], v[244:247]
    v_mfma_f32_16x16x32_bf16 v[232:235], v[160:163], v[228:231], v[232:235]
    v_mfma_f32_16x16x32_bf16 v[236:239], v[164:167], v[228:231], v[236:239]
    v_mfma_f32_16x16x32_bf16 v[240:243], v[168:171], v[228:231], v[240:243]
    v_mfma_f32_16x16x32_bf16 v[244:247], v[172:175], v[228:231], v[244:247]
    s_nop 7
    s_nop 1
    v_add_f32_dpp v232, v232, v232 row_ror:2 row_mask:0xf bank_mask:0xf
    v_add_f32_dpp v233, v233, v233 row_ror:2 row_mask:0xf bank_mask:0xf
    v_add_f32_dpp v234, v234, v234 row_ror:2 row_mask:0xf bank_mask:0xf
    v_add_f32_dpp v235, v235, v235 row_ror:2 row_mask:0xf bank_mask:0xf
    v_add_f32_dpp v236, v236, v236 row_ror:2 row_mask:0xf bank_mask:0xf
    v_add_f32_dpp v237, v237, v237 row_ror:2 row_mask:0xf bank_mask:0xf
    v_add_f32_dpp v238, v238, v238 row_ror:2 row_mask:0xf bank_mask:0xf
    v_add_f32_dpp v239, v239, v239 row_ror:2 row_mask:0xf bank_mask:0xf
    v_add_f32_dpp v240, v240, v240 row_ror:2 row_mask:0xf bank_mask:0xf
    v_add_f32_dpp v241, v241, v241 row_ror:2 row_mask:0xf bank_mask:0xf
    v_add_f32_dpp v242, v242, v242 row_ror:2 row_mask:0xf bank_mask:0xf
    v_add_f32_dpp v243, v243, v243 row_ror:2 row_mask:0xf bank_mask:0xf
    v_add_f32_dpp v244, v244, v244 row_ror:2 row_mask:0xf bank_mask:0xf
    v_add_f32_dpp v245, v245, v245 row_ror:2 row_mask:0xf bank_mask:0xf
    v_add_f32_dpp v246, v246, v246 row_ror:2 row_mask:0xf bank_mask:0xf
    v_add_f32_dpp v247, v247, v247 row_ror:2 row_mask:0xf bank_mask:0xf
    v_add_f32_dpp v232, v232, v232 row_ror:4 row_mask:0xf bank_mask:0xf
    v_add_f32_dpp v233, v233, v233 row_ror:4 row_mask:0xf bank_mask:0xf
    v_add_f32_dpp v234, v234, v234 row_ror:4 row_mask:0xf bank_mask:0xf
    v_add_f32_dpp v235, v235, v235 row_ror:4 row_mask:0xf bank_mask:0xf
    v_add_f32_dpp v236, v236, v236 row_ror:4 row_mask:0xf bank_mask:0xf
    v_add_f32_dpp v237, v237, v237 row_ror:4 row_mask:0xf bank_mask:0xf
    v_add_f32_dpp v238, v238, v238 row_ror:4 row_mask:0xf bank_mask:0xf
    v_add_f32_dpp v239, v239, v239 row_ror:4 row_mask:0xf bank_mask:0xf
    v_add_f32_dpp v240, v240, v240 row_ror:4 row_mask:0xf bank_mask:0xf
    v_add_f32_dpp v241, v241, v241 row_ror:4 row_mask:0xf bank_mask:0xf
    v_add_f32_dpp v242, v242, v242 row_ror:4 row_mask:0xf bank_mask:0xf
    v_add_f32_dpp v243, v243, v243 row_ror:4 row_mask:0xf bank_mask:0xf
    v_add_f32_dpp v244, v244, v244 row_ror:4 row_mask:0xf bank_mask:0xf
    v_add_f32_dpp v245, v245, v245 row_ror:4 row_mask:0xf bank_mask:0xf
    v_add_f32_dpp v246, v246, v246 row_ror:4 row_mask:0xf bank_mask:0xf
    v_add_f32_dpp v247, v247, v247 row_ror:4 row_mask:0xf bank_mask:0xf
    v_lshl_add_u32 v248, v2, 1, v1
    v_lshlrev_b32 v248, 4, v248
    s_lshl_b32 s4, s79, 9
    s_add_u32 s4, s4, 86016
    v_add_u32 v248, s4, v248
    s_mov_b32 exec_lo, 0x30003
    s_mov_b32 exec_hi, 0x30003
    ds_write_b128 v248, v[232:235] offset:0
    ds_write_b128 v248, v[236:239] offset:128
    ds_write_b128 v248, v[240:243] offset:256
    ds_write_b128 v248, v[244:247] offset:384
    s_mov_b64 exec, -1
    s_waitcnt lgkmcnt(0)
    s_barrier
    s_cmp_lg_u32 s79, 0
    s_cbranch_scc1 L_p5_done
    s_mov_b64 exec, 0xffffffff
    v_lshlrev_b32 v216, 4, v0
    v_add_u32 v216, 86016, v216
    ds_read_b128 v[200:203], v216 offset:0
    ds_read_b128 v[204:207], v216 offset:512
    ds_read_b128 v[208:211], v216 offset:1024
    ds_read_b128 v[212:215], v216 offset:1536
    s_waitcnt lgkmcnt(0)
    v_add_f32 v200, v200, v204
    v_add_f32 v208, v208, v212
    v_add_f32 v201, v201, v205
    v_add_f32 v209, v209, v213
    v_add_f32 v202, v202, v206
    v_add_f32 v210, v210, v214
    v_add_f32 v203, v203, v207
    v_add_f32 v211, v211, v215
    v_add_f32 v200, v200, v208
    v_add_f32 v201, v201, v209
    v_add_f32 v202, v202, v210
    v_add_f32 v203, v203, v211
    v_fma_f32 v200, v192, v200, v196
    v_fma_f32 v201, v193, v201, v197
    v_fma_f32 v202, v194, v202, v198
    v_fma_f32 v203, v195, v203, v199
    v_or_b32 v200, 1, v200
    buffer_store_dwordx4 v[200:203], v190, s[72:75], 0 offen offset:0 sc1
    s_mov_b64 exec, -1
L_p5_done:
    s_branch L_back_end
L_t_not5:
    s_cmp_lt_u32 s80, 9
    s_cbranch_scc1 L_t_p7
    s_cmp_ge_u32 s93, 54
    s_cbranch_scc1 L_back_end
    v_min_u32 v184, 39, v0
    v_lshlrev_b32 v185, 4, v184
    s_mul_i32 s4, s79, 640
    v_add_u32 v185, s4, v185
    v_add_u32 v186, 379392, v185
    v_add_u32 v187, 10240, v186
    s_mul_i32 s4, s79, 40
    v_add_u32 v198, s4, v184
    v_lshrrev_b32 v188, 2, v198
    v_lshlrev_b32 v188, 7, v188
    v_and_b32 v198, 3, v198
    v_lshl_add_u32 v188, v198, 5, v188
    v_add_u32 v188, 344064, v188
    v_add_u32 v189, 5120, v188
    v_add_u32 v190, 5120, v189
    v_add_u32 v191, 5120, v190
    v_lshlrev_b32 v196, 3, v184
    s_mul_i32 s4, s79, 672
    s_add_u32 s4, s4, 88576
    v_add_u32 v196, s4, v196
    v_and_b32 v197, 15, v0
    v_lshrrev_b32 v197, 1, v197
    v_lshlrev_b32 v197, 3, v197
    s_lshl_b32 s4, s93, 6
    v_add_u32 v197, s4, v197
    buffer_load_dwordx2 v[192:193], v197, s[44:47], 0 offen offset:0
    v_add_u32 v194, s4, v197
    v_lshl_add_u32 v194, v10, 6, v194
    v_add_u32 v194, 368640, v194
    v_and_b32 v195, 1, v1
    v_mul_u32_u24 v195, 336, v195
    v_lshl_add_u32 v195, v2, 4, v195
    s_mul_i32 s4, s79, 672
    s_add_u32 s4, s4, 88576
    v_add_u32 v195, s4, v195
    v_cmp_gt_u32 s[10:11], 40, v0
L_sc:
    buffer_load_dwordx4 v[144:147], v186, s[72:75], 0 offen offset:0 sc1
    buffer_load_dwordx4 v[152:155], v186, s[72:75], 0 offen offset:2560 sc1
    buffer_load_dwordx4 v[148:151], v187, s[72:75], 0 offen offset:0 sc1
    buffer_load_dwordx4 v[156:159], v187, s[72:75], 0 offen offset:2560 sc1
    s_waitcnt vmcnt(0)
    v_and_b32 v198, v144, v148
    v_and_b32 v198, v198, v152
    v_and_b32 v198, v198, v156
    v_and_b32 v198, 1, v198
    v_cmp_eq_u32 vcc, 0, v198
    s_cbranch_vccz L_sc_done
    s_sleep 1
    s_add_u32 s87, s87, 1
    s_cmp_lt_u32 s87, 400000
    s_cbranch_scc1 L_sc
    s_branch L_bail
L_sc_done:
    v_add_f32 v152, 1.0, v152
    v_add_f32 v153, 1.0, v153
    v_add_f32 v154, 1.0, v154
    v_add_f32 v155, 1.0, v155
    v_add_f32 v156, 1.0, v156
    v_add_f32 v157, 1.0, v157
    v_add_f32 v158, 1.0, v158
    v_add_f32 v159, 1.0, v159
    v_mov_b32 v198, 278512
    s_mov_b64 exec, 0x1
L_lp_46:
    buffer_load_dwordx4 v[200:203], v198, s[72:75], 0 offen offset:0 sc1
    s_waitcnt vmcnt(0)
    v_and_b32 v200, v200, v202
    v_and_b32 v200, 1, v200
    v_cmp_eq_u32 vcc, 0, v200
    s_cbranch_vccz L_lp_done_47
    s_sleep 1
    s_add_u32 s87, s87, 1
    s_cmp_lt_u32 s87, 400000
    s_cbranch_scc1 L_lp_46
    s_branch L_bail
L_lp_done_47:
    s_mov_b64 exec, -1
    s_mov_b32 s96, 255
L_gp_48:
    s_bitcmp1_b32 s96, 0
    s_cbranch_scc0 L_gs__50
    buffer_load_dwordx4 v[200:203], v188, s[72:75], 0 offen offset:0 sc1
L_gs__50:
    s_bitcmp1_b32 s96, 1
    s_cbranch_scc0 L_gs__51
    buffer_load_dwordx4 v[204:207], v188, s[72:75], 0 offen offset:16 sc1
L_gs__51:
    s_bitcmp1_b32 s96, 2
    s_cbranch_scc0 L_gs__52
    buffer_load_dwordx4 v[208:211], v189, s[72:75], 0 offen offset:0 sc1
L_gs__52:
    s_bitcmp1_b32 s96, 3
    s_cbranch_scc0 L_gs__53
    buffer_load_dwordx4 v[212:215], v189, s[72:75], 0 offen offset:16 sc1
L_gs__53:
    s_bitcmp1_b32 s96, 4
    s_cbranch_scc0 L_gs__54
    buffer_load_dwordx4 v[216:219], v190, s[72:75], 0 offen offset:0 sc1
L_gs__54:
    s_bitcmp1_b32 s96, 5
    s_cbranch_scc0 L_gs__55
    buffer_load_dwordx4 v[220:223], v190, s[72:75], 0 offen offset:16 sc1
L_gs__55:
    s_bitcmp1_b32 s96, 6
    s_cbranch_scc0 L_gs__56
    buffer_load_dwordx4 v[224:227], v191, s[72:75], 0 offen offset:0 sc1
L_gs__56:
    s_bitcmp1_b32 s96, 7
    s_cbranch_scc0 L_gs__57
    buffer_load_dwordx4 v[228:231], v191, s[72:75], 0 offen offset:16 sc1
L_gs__57:
    s_waitcnt vmcnt(0)
    s_bitcmp1_b32 s96, 0
    s_cbranch_scc0 L_gc__58
    v_and_b32 v198, 1, v200
    v_cmp_eq_u32 vcc, 0, v198
    s_cbranch_vccnz L_gc__58
    s_bitset0_b32 s96, 0
L_gc__58:
    s_bitcmp1_b32 s96, 1
    s_cbranch_scc0 L_gc__59
    v_and_b32 v198, 1, v204
    v_cmp_eq_u32 vcc, 0, v198
    s_cbranch_vccnz L_gc__59
    s_bitset0_b32 s96, 1
L_gc__59:
    s_bitcmp1_b32 s96, 2
    s_cbranch_scc0 L_gc__60
    v_and_b32 v198, 1, v208
    v_cmp_eq_u32 vcc, 0, v198
    s_cbranch_vccnz L_gc__60
    s_bitset0_b32 s96, 2
L_gc__60:
    s_bitcmp1_b32 s96, 3
    s_cbranch_scc0 L_gc__61
    v_and_b32 v198, 1, v212
    v_cmp_eq_u32 vcc, 0, v198
    s_cbranch_vccnz L_gc__61
    s_bitset0_b32 s96, 3
L_gc__61:
    s_bitcmp1_b32 s96, 4
    s_cbranch_scc0 L_gc__62
    v_and_b32 v198, 1, v216
    v_cmp_eq_u32 vcc, 0, v198
    s_cbranch_vccnz L_gc__62
    s_bitset0_b32 s96, 4
L_gc__62:
    s_bitcmp1_b32 s96, 5
    s_cbranch_scc0 L_gc__63
    v_and_b32 v198, 1, v220
    v_cmp_eq_u32 vcc, 0, v198
    s_cbranch_vccnz L_gc__63
    s_bitset0_b32 s96, 5
L_gc__63:
    s_bitcmp1_b32 s96, 6
    s_cbranch_scc0 L_gc__64
    v_and_b32 v198, 1, v224
    v_cmp_eq_u32 vcc, 0, v198
    s_cbranch_vccnz L_gc__64
    s_bitset0_b32 s96, 6
L_gc__64:
    s_bitcmp1_b32 s96, 7
    s_cbranch_scc0 L_gc__65
    v_and_b32 v198, 1, v228
    v_cmp_eq_u32 vcc, 0, v198
    s_cbranch_vccnz L_gc__65
    s_bitset0_b32 s96, 7
L_gc__65:
    s_cmp_eq_u32 s96, 0
    s_cbranch_scc1 L_gp_done_49
    s_add_u32 s87, s87, 1
    s_cmp_lt_u32 s87, 400000
    s_cbranch_scc1 L_gp_48
    s_branch L_bail
L_gp_done_49:
    v_add_f32 v200, v200, v208
    v_add_f32 v216, v216, v224
    v_add_f32 v201, v201, v209
    v_add_f32 v217, v217, v225
    v_add_f32 v202, v202, v210
    v_add_f32 v218, v218, v226
    v_add_f32 v203, v203, v211
    v_add_f32 v219, v219, v227
    v_add_f32 v204, v204, v212
    v_add_f32 v220, v220, v228
    v_add_f32 v205, v205, v213
    v_add_f32 v221, v221, v229
    v_add_f32 v206, v206, v214
    v_add_f32 v222, v222, v230
    v_add_f32 v207, v207, v215
    v_add_f32 v223, v223, v231
    v_add_f32 v200, v200, v216
    v_add_f32 v201, v201, v217
    v_add_f32 v202, v202, v218
    v_add_f32 v203, v203, v219
    v_add_f32 v204, v204, v220
    v_add_f32 v205, v205, v221
    v_add_f32 v206, v206, v222
    v_add_f32 v207, v207, v223
    v_add_f32 v232, v200, v201
    v_mul_f32 v233, v200, v200
    v_add_f32 v232, v232, v202
    v_fmac_f32 v233, v201, v201
    v_add_f32 v232, v232, v203
    v_fmac_f32 v233, v202, v202
    v_fmac_f32 v233, v203, v203
    v_add_f32 v234, v204, v205
    v_mul_f32 v235, v204, v204
    v_add_f32 v234, v234, v206
    v_fmac_f32 v235, v205, v205
    v_add_f32 v234, v234, v207
    v_fmac_f32 v235, v206, v206
    v_fmac_f32 v235, v207, v207
    v_cndmask_b32 v232, 0, v232, s[10:11]
    v_cndmask_b32 v233, 0, v233, s[10:11]
    v_cndmask_b32 v234, 0, v234, s[10:11]
    v_cndmask_b32 v235, 0, v235, s[10:11]
    v_add_f32_dpp v232, v232, v232 row_ror:8 row_mask:0xf bank_mask:0xf
    v_add_f32_dpp v233, v233, v233 row_ror:8 row_mask:0xf bank_mask:0xf
    v_add_f32_dpp v234, v234, v234 row_ror:8 row_mask:0xf bank_mask:0xf
    v_add_f32_dpp v235, v235, v235 row_ror:8 row_mask:0xf bank_mask:0xf
    v_add_f32_dpp v232, v232, v232 row_ror:4 row_mask:0xf bank_mask:0xf
    v_add_f32_dpp v233, v233, v233 row_ror:4 row_mask:0xf bank_mask:0xf
    v_add_f32_dpp v234, v234, v234 row_ror:4 row_mask:0xf bank_mask:0xf
    v_add_f32_dpp v235, v235, v235 row_ror:4 row_mask:0xf bank_mask:0xf
    v_add_f32_dpp v232, v232, v232 row_ror:2 row_mask:0xf bank_mask:0xf
    v_add_f32_dpp v233, v233, v233 row_ror:2 row_mask:0xf bank_mask:0xf
    v_add_f32_dpp v234, v234, v234 row_ror:2 row_mask:0xf bank_mask:0xf
    v_add_f32_dpp v235, v235, v235 row_ror:2 row_mask:0xf bank_mask:0xf
    v_add_f32_dpp v232, v232, v232 row_ror:1 row_mask:0xf bank_mask:0xf
    v_add_f32_dpp v233, v233, v233 row_ror:1 row_mask:0xf bank_mask:0xf
    v_add_f32_dpp v234, v234, v234 row_ror:1 row_mask:0xf bank_mask:0xf
    v_add_f32_dpp v235, v235, v235 row_ror:1 row_mask:0xf bank_mask:0xf
    v_mov_b32 v236, v232
    v_mov_b32 v237, v233
    v_mov_b32 v238, v234
    v_mov_b32 v239, v235
    s_nop 0
    v_permlane16_swap_b32 v232, v236
    v_permlane16_swap_b32 v233, v237
    v_permlane16_swap_b32 v234, v238
    v_permlane16_swap_b32 v235, v239
    s_nop 0
    v_add_f32 v232, v232, v236
    v_add_f32 v233, v233, v237
    v_add_f32 v234, v234, v238
    v_add_f32 v235, v235, v239
    v_mov_b32 v236, v232
    v_mov_b32 v237, v233
    v_mov_b32 v238, v234
    v_mov_b32 v239, v235
    s_nop 0
    v_permlane32_swap_b32 v232, v236
    v_permlane32_swap_b32 v233, v237
    v_permlane32_swap_b32 v234, v238
    v_permlane32_swap_b32 v235, v239
    s_nop 0
    v_add_f32 v232, v232, v236
    v_add_f32 v233, v233, v237
    v_add_f32 v234, v234, v238
    v_add_f32 v235, v235, v239
    s_lshl_b32 s4, s79, 4
    s_add_u32 s4, s4, 88064
    v_mov_b32 v236, s4
    s_mov_b64 exec, 1
    ds_write_b128 v236, v[232:235]
    s_mov_b64 exec, -1
    s_waitcnt lgkmcnt(0)
    s_barrier
    v_mov_b32 v236, 88064
    ds_read_b128 v[240:243], v236 offset:0
    ds_read_b128 v[244:247], v236 offset:16
    ds_read_b128 v[248:251], v236 offset:32
    ds_read_b128 v[252:255], v236 offset:48
    s_waitcnt lgkmcnt(0)
    v_add_f32 v240, v240, v244
    v_add_f32 v248, v248, v252
    v_add_f32 v241, v241, v245
    v_add_f32 v249, v249, v253
    v_add_f32 v242, v242, v246
    v_add_f32 v250, v250, v254
    v_add_f32 v243, v243, v247
    v_add_f32 v251, v251, v255
    v_add_f32 v232, v240, v248
    v_add_f32 v233, v241, v249
    v_add_f32 v234, v242, v250
    v_add_f32 v235, v243, v251
    v_mul_f32 v232, 0x3acccccd, v232
    v_mul_f32 v233, 0x3acccccd, v233
    v_fma_f32 v233, -v232, v232, v233
    v_max_f32 v233, 0, v233
    v_add_f32 v233, 0x3727c5ac, v233
    v_rsq_f32 v233, v233
    v_mul_f32 v234, 0x3acccccd, v234
    v_mul_f32 v235, 0x3acccccd, v235
    v_fma_f32 v235, -v234, v234, v235
    v_max_f32 v235, 0, v235
    v_add_f32 v235, 0x3727c5ac, v235
    v_rsq_f32 v235, v235
    s_nop 0
    v_sub_f32 v200, v200, v232
    v_mul_f32 v200, v200, v233
    v_fma_f32 v200, v200, v152, v144
    v_sub_f32 v201, v201, v232
    v_mul_f32 v201, v201, v233
    v_fma_f32 v201, v201, v153, v145
    v_sub_f32 v202, v202, v232
    v_mul_f32 v202, v202, v233
    v_fma_f32 v202, v202, v154, v146
    v_sub_f32 v203, v203, v232
    v_mul_f32 v203, v203, v233
    v_fma_f32 v203, v203, v155, v147
    v_cvt_pk_bf16_f32 v240, v200, v201
    v_cvt_pk_bf16_f32 v241, v202, v203
    ds_write_b64 v196, v[240:241] offset:0
    v_sub_f32 v204, v204, v234
    v_mul_f32 v204, v204, v235
    v_fma_f32 v204, v204, v156, v148
    v_sub_f32 v205, v205, v234
    v_mul_f32 v205, v205, v235
    v_fma_f32 v205, v205, v157, v149
    v_sub_f32 v206, v206, v234
    v_mul_f32 v206, v206, v235
    v_fma_f32 v206, v206, v158, v150
    v_sub_f32 v207, v207, v234
    v_mul_f32 v207, v207, v235
    v_fma_f32 v207, v207, v159, v151
    v_cvt_pk_bf16_f32 v242, v204, v205
    v_cvt_pk_bf16_f32 v243, v206, v207
    ds_write_b64 v196, v[242:243] offset:336
    ds_read_b128 v[200:203], v195 offset:0
    ds_read_b128 v[204:207], v195 offset:64
    ds_read_b128 v[208:211], v195 offset:128
    ds_read_b128 v[212:215], v195 offset:192
    ds_read_b128 v[216:219], v195 offset:256
    s_waitcnt lgkmcnt(0)
    v_mfma_f32_16x16x32_bf16 v[224:227], v[104:107], v[200:203], 0
    v_mfma_f32_16x16x32_bf16 v[228:231], v[108:111], v[200:203], 0
    v_mfma_f32_16x16x32_bf16 v[224:227], v[112:115], v[204:207], v[224:227]
    v_mfma_f32_16x16x32_bf16 v[228:231], v[116:119], v[204:207], v[228:231]
    v_mfma_f32_16x16x32_bf16 v[224:227], v[120:123], v[208:211], v[224:227]
    v_mfma_f32_16x16x32_bf16 v[228:231], v[124:127], v[208:211], v[228:231]
    v_mfma_f32_16x16x32_bf16 v[224:227], v[128:131], v[212:215], v[224:227]
    v_mfma_f32_16x16x32_bf16 v[228:231], v[132:135], v[212:215], v[228:231]
    v_mfma_f32_16x16x32_bf16 v[224:227], v[136:139], v[216:219], v[224:227]
    v_mfma_f32_16x16x32_bf16 v[228:231], v[140:143], v[216:219], v[228:231]
    s_nop 7
    s_nop 1
    v_lshl_add_u32 v198, v2, 1, v1
    v_lshlrev_b32 v198, 4, v198
    s_lshl_b32 s4, s79, 9
    s_add_u32 s4, s4, 86016
    v_add_u32 v198, s4, v198
    s_mov_b32 exec_lo, 0x30003
    s_mov_b32 exec_hi, 0x30003
    ds_write_b128 v198, v[224:227] offset:0
    ds_write_b128 v198, v[228:231] offset:128
    s_mov_b64 exec, -1
    s_waitcnt lgkmcnt(0)
    s_barrier
    s_cmp_lg_u32 s79, 0
    s_cbranch_scc1 L_p6_done
    s_mov_b64 exec, 0xffff
    v_lshlrev_b32 v216, 4, v0
    v_add_u32 v216, 86016, v216
    ds_read_b128 v[200:203], v216 offset:0
    ds_read_b128 v[204:207], v216 offset:512
    ds_read_b128 v[208:211], v216 offset:1024
    ds_read_b128 v[212:215], v216 offset:1536
    s_waitcnt lgkmcnt(0)
    v_add_f32 v200, v200, v204
    v_add_f32 v208, v208, v212
    v_add_f32 v201, v201, v205
    v_add_f32 v209, v209, v213
    v_add_f32 v202, v202, v206
    v_add_f32 v210, v210, v214
    v_add_f32 v203, v203, v207
    v_add_f32 v211, v211, v215
    v_add_f32 v200, v200, v208
    v_add_f32 v201, v201, v209
    v_add_f32 v202, v202, v210
    v_add_f32 v203, v203, v211
    v_lshlrev_b32 v220, 16, v192
    v_and_b32 v221, 0xffff0000, v192
    v_lshlrev_b32 v222, 16, v193
    v_and_b32 v223, 0xffff0000, v193
    v_add_f32 v200, v200, v220
    v_max_f32 v200, 0, v200
    v_mul_f32 v200, v200, v200
    v_add_f32 v201, v201, v221
    v_max_f32 v201, 0, v201
    v_mul_f32 v201, v201, v201
    v_add_f32 v202, v202, v222
    v_max_f32 v202, 0, v202
    v_mul_f32 v202, v202, v202
    v_add_f32 v203, v203, v223
    v_max_f32 v203, 0, v203
    v_mul_f32 v203, v203, v203
    v_cvt_pk_bf16_f32 v204, v200, v201
    v_cvt_pk_bf16_f32 v205, v202, v203
    v_or_b32 v204, 1, v204
    buffer_store_dwordx2 v[204:205], v194, s[72:75], 0 offen offset:0 sc1
    s_mov_b64 exec, -1
L_p6_done:
    s_cmp_lg_u32 s80, 9
    s_cbranch_scc1 L_back_end
L_t_p7:
    v_and_b32 v184, 7, v0
    v_lshrrev_b32 v185, 1, v184
    v_mul_u32_u24 v186, 10240, v10
    v_lshl_add_u32 v186, v185, 4, v186
    s_lshl_b32 s4, s92, 6
    s_add_u32 s5, s4, 384512
    v_add_u32 v186, s5, v186
    v_lshlrev_b32 v187, 4, v184
    s_lshl_b32 s5, s92, 7
    s_add_u32 s5, s5, 344064
    v_add_u32 v187, s5, v187
    v_add_u32 v244, 5120, v187
    v_add_u32 v245, 5120, v244
    v_add_u32 v246, 5120, v245
    v_lshlrev_b32 v188, 3, v185
    s_lshl_b32 s4, s92, 5
    v_add_u32 v188, s4, v188
    buffer_load_dwordx2 v[190:191], v188, s[52:55], 0 offen offset:0
    v_mul_u32_u24 v189, 1280, v10
    v_add_u32 v189, v189, v188
L_gb:
    buffer_load_dwordx4 v[192:195], v186, s[72:75], 0 offen offset:0 sc1
    buffer_load_dwordx4 v[216:219], v187, s[72:75], 0 offen offset:0 sc1
    buffer_load_dwordx4 v[220:223], v244, s[72:75], 0 offen offset:0 sc1
    buffer_load_dwordx4 v[224:227], v245, s[72:75], 0 offen offset:0 sc1
    buffer_load_dwordx4 v[228:231], v246, s[72:75], 0 offen offset:0 sc1
    s_waitcnt vmcnt(0)
    v_and_b32 v196, v192, v216
    v_and_b32 v196, v196, v220
    v_and_b32 v196, v196, v224
    v_and_b32 v196, v196, v228
    v_and_b32 v196, 1, v196
    v_cmp_eq_u32 vcc, 0, v196
    s_cbranch_vccz L_gb_done
    s_sleep 1
    s_add_u32 s87, s87, 1
    s_cmp_lt_u32 s87, 400000
    s_cbranch_scc1 L_gb
    s_branch L_bail
L_gb_done:
    v_add_f32 v216, v216, v220
    v_add_f32 v224, v224, v228
    v_add_f32 v217, v217, v221
    v_add_f32 v225, v225, v229
    v_add_f32 v218, v218, v222
    v_add_f32 v226, v226, v230
    v_add_f32 v219, v219, v223
    v_add_f32 v227, v227, v231
    v_add_f32 v212, v216, v224
    v_add_f32 v213, v217, v225
    v_add_f32 v214, v218, v226
    v_add_f32 v215, v219, v227
    v_min_u32 v197, 55, v0
    s_mul_i32 s4, s79, 56
    v_add_u32 v198, s4, v197
    v_min_u32 v199, 215, v198
    v_and_b32 v200, 3, v199
    v_lshrrev_b32 v199, 2, v199
    v_lshlrev_b32 v199, 7, v199
    v_lshl_add_u32 v199, v200, 4, v199
    v_add_u32 v199, 368640, v199
    v_lshlrev_b32 v200, 4, v198
    v_add_u32 v200, 91264, v200
    v_and_b32 v201, 1, v1
    v_mul_u32_u24 v201, 3648, v201
    v_lshl_add_u32 v201, v2, 4, v201
    s_mul_i32 s4, s79, 896
    s_add_u32 s4, s4, 91264
    v_add_u32 v201, s4, v201
    s_movk_i32 s10, 216
    v_cmp_gt_u32 s[8:9], s10, v198
    s_mov_b32 s96, 3
L_gp_66:
    s_bitcmp1_b32 s96, 0
    s_cbranch_scc0 L_gs__68
    buffer_load_dwordx4 v[204:207], v199, s[72:75], 0 offen offset:0 sc1
L_gs__68:
    s_bitcmp1_b32 s96, 1
    s_cbranch_scc0 L_gs__69
    buffer_load_dwordx4 v[208:211], v199, s[72:75], 0 offen offset:64 sc1
L_gs__69:
    s_waitcnt vmcnt(0)
    s_bitcmp1_b32 s96, 0
    s_cbranch_scc0 L_gc__70
    v_and_b32 v196, v204, v206
    v_and_b32 v196, 1, v196
    v_cmp_eq_u32 vcc, 0, v196
    s_cbranch_vccnz L_gc__70
    s_bitset0_b32 s96, 0
L_gc__70:
    s_bitcmp1_b32 s96, 1
    s_cbranch_scc0 L_gc__71
    v_and_b32 v196, v208, v210
    v_and_b32 v196, 1, v196
    v_cmp_eq_u32 vcc, 0, v196
    s_cbranch_vccnz L_gc__71
    s_bitset0_b32 s96, 1
L_gc__71:
    s_cmp_eq_u32 s96, 0
    s_cbranch_scc1 L_gp_done_67
    s_add_u32 s87, s87, 1
    s_cmp_lt_u32 s87, 400000
    s_cbranch_scc1 L_gp_66
    s_branch L_bail
L_gp_done_67:
    v_cndmask_b32 v204, 0, v204, s[8:9]
    v_cndmask_b32 v205, 0, v205, s[8:9]
    v_cndmask_b32 v206, 0, v206, s[8:9]
    v_cndmask_b32 v207, 0, v207, s[8:9]
    v_cndmask_b32 v208, 0, v208, s[8:9]
    v_cndmask_b32 v209, 0, v209, s[8:9]
    v_cndmask_b32 v210, 0, v210, s[8:9]
    v_cndmask_b32 v211, 0, v211, s[8:9]
    ds_write_b128 v200, v[204:207]
    ds_write_b128 v200, v[208:211] offset:3648
    ds_read_b128 v[216:219], v201 offset:0
    ds_read_b128 v[220:223], v201 offset:64
    ds_read_b128 v[224:227], v201 offset:128
    ds_read_b128 v[228:231], v201 offset:192
    ds_read_b128 v[232:235], v201 offset:256
    ds_read_b128 v[236:239], v201 offset:320
    ds_read_b128 v[240:243], v201 offset:384
    ds_read_b128 v[244:247], v201 offset:448
    s_waitcnt lgkmcnt(7)
    v_mfma_f32_16x16x32_bf16 v[248:251], v[48:51], v[216:219], 0
    ds_read_b128 v[216:219], v201 offset:512
    s_waitcnt lgkmcnt(7)
    v_mfma_f32_16x16x32_bf16 v[248:251], v[52:55], v[220:223], v[248:251]
    ds_read_b128 v[220:223], v201 offset:576
    s_waitcnt lgkmcnt(7)
    v_mfma_f32_16x16x32_bf16 v[248:251], v[56:59], v[224:227], v[248:251]
    ds_read_b128 v[224:227], v201 offset:640
    s_waitcnt lgkmcnt(7)
    v_mfma_f32_16x16x32_bf16 v[248:251], v[60:63], v[228:231], v[248:251]
    ds_read_b128 v[228:231], v201 offset:704
    s_waitcnt lgkmcnt(7)
    v_mfma_f32_16x16x32_bf16 v[248:251], v[64:67], v[232:235], v[248:251]
    ds_read_b128 v[232:235], v201 offset:768
    s_waitcnt lgkmcnt(7)
    v_mfma_f32_16x16x32_bf16 v[248:251], v[68:71], v[236:239], v[248:251]
    ds_read_b128 v[236:239], v201 offset:832
    s_waitcnt lgkmcnt(7)
    v_mfma_f32_16x16x32_bf16 v[248:251], v[72:75], v[240:243], v[248:251]
    s_waitcnt lgkmcnt(6)
    v_mfma_f32_16x16x32_bf16 v[248:251], v[76:79], v[244:247], v[248:251]
    s_waitcnt lgkmcnt(5)
    v_mfma_f32_16x16x32_bf16 v[248:251], v[80:83], v[216:219], v[248:251]
    s_waitcnt lgkmcnt(4)
    v_mfma_f32_16x16x32_bf16 v[248:251], v[84:87], v[220:223], v[248:251]
    s_waitcnt lgkmcnt(3)
    v_mfma_f32_16x16x32_bf16 v[248:251], v[88:91], v[224:227], v[248:251]
    s_waitcnt lgkmcnt(2)
    v_mfma_f32_16x16x32_bf16 v[248:251], v[92:95], v[228:231], v[248:251]
    s_waitcnt lgkmcnt(1)
    v_mfma_f32_16x16x32_bf16 v[248:251], v[96:99], v[232:235], v[248:251]
    s_waitcnt lgkmcnt(0)
    v_mfma_f32_16x16x32_bf16 v[248:251], v[100:103], v[236:239], v[248:251]
    s_nop 7
    s_nop 1
    v_lshl_add_u32 v196, v2, 1, v1
    v_lshlrev_b32 v196, 4, v196
    s_lshl_b32 s4, s79, 9
    s_add_u32 s4, s4, 86016
    v_add_u32 v196, s4, v196
    s_mov_b32 exec_lo, 0x30003
    s_mov_b32 exec_hi, 0x30003
    ds_write_b128 v196, v[248:251] offset:0
    s_mov_b64 exec, -1
    s_waitcnt lgkmcnt(0)
    s_barrier
    s_cmp_lg_u32 s79, 0
    s_cbranch_scc1 L_p7_done
    s_mov_b64 exec, 0xff
    v_lshlrev_b32 v236, 4, v0
    v_add_u32 v236, 86016, v236
    ds_read_b128 v[220:223], v236 offset:0
    ds_read_b128 v[224:227], v236 offset:512
    ds_read_b128 v[228:231], v236 offset:1024
    ds_read_b128 v[232:235], v236 offset:1536
    s_waitcnt lgkmcnt(0)
    v_add_f32 v220, v220, v224
    v_add_f32 v228, v228, v232
    v_add_f32 v221, v221, v225
    v_add_f32 v229, v229, v233
    v_add_f32 v222, v222, v226
    v_add_f32 v230, v230, v234
    v_add_f32 v223, v223, v227
    v_add_f32 v231, v231, v235
    v_add_f32 v220, v220, v228
    v_add_f32 v221, v221, v229
    v_add_f32 v222, v222, v230
    v_add_f32 v223, v223, v231
    v_lshlrev_b32 v240, 16, v190
    v_and_b32 v241, 0xffff0000, v190
    v_lshlrev_b32 v242, 16, v191
    v_and_b32 v243, 0xffff0000, v191
    v_add_f32 v220, v220, v240
    v_fma_f32 v220, v192, v220, v212
    v_add_f32 v221, v221, v241
    v_fma_f32 v221, v193, v221, v213
    v_add_f32 v222, v222, v242
    v_fma_f32 v222, v194, v222, v214
    v_add_f32 v223, v223, v243
    v_fma_f32 v223, v195, v223, v215
    v_cvt_pk_bf16_f32 v224, v220, v221
    v_cvt_pk_bf16_f32 v225, v222, v223
    buffer_store_dwordx2 v[224:225], v189, s[64:67], 0 offen offset:0
    s_cmp_lg_u32 s92, 0
    s_cbranch_scc1 L_p7_noep
    s_mov_b64 exec, 1
    v_mov_b32 v228, s88
    v_mov_b32 v229, s89
    v_mov_b32 v230, 0
    buffer_store_dwordx2 v[228:229], v230, s[72:75], 0 offen offset:2048
L_p7_noep:
    s_mov_b64 exec, -1
L_p7_done:
L_back_end:
    s_branch L_wave_end
L_att:
    s_cmp_lg_u32 s78, 0
    s_cbranch_scc1 L_a_noinit
    v_lshlrev_b32 v100, 2, v1
    v_add_u32 v100, 158976, v100
    v_mov_b32 v102, 0
    ds_write_b32 v100, v102
    s_waitcnt lgkmcnt(0)
L_a_noinit:
    s_lshr_b32 s81, s77, 1
    s_lshl_b32 s4, s76, 3
    s_add_u32 s81, s81, s4
    s_lshr_b32 s84, s81, 5
    s_and_b32 s85, s81, 31
    s_and_b32 s86, s77, 1
    s_lshl_b32 s4, s76, 4
    s_add_u32 s4, s4, s77
    s_lshr_b32 s93, s4, 2
    s_and_b32 s94, s4, 3
    s_cmp_ge_u32 s78, 4
    s_cbranch_scc1 L_a_back
    s_lshl_b32 s4, s76, 4
    s_add_u32 s14, s4, s77
    s_mul_i32 s4, s14, 3072
    s_lshl_b32 s5, s79, 10
    s_add_u32 s4, s4, s5
    s_add_u32 s4, s4, 65536
    v_lshlrev_b32 v100, 4, v0
    v_add_u32 v100, s4, v100
    v_mov_b32 v104, 0
    v_mov_b32 v105, 0
    v_mov_b32 v106, 0
    v_mov_b32 v107, 0
    s_cmp_eq_u32 s79, 3
    s_cbranch_scc1 L_a_noz
    buffer_store_dwordx4 v[104:107], v100, s[72:75], 0 offen offset:0 sc1
L_a_noz:
    s_barrier
    s_waitcnt vmcnt(0)
    v_readfirstlane_b32 s88, v254
    v_readfirstlane_b32 s89, v255
    s_nop 3
    s_add_u32 s88, s88, 1
    s_addc_u32 s89, s89, 0
    s_mov_b64 exec, 1
    v_mov_b32 v100, 159008
    v_mov_b32 v102, 1
    ds_add_u32 v100, v102
L_gs_72:
    ds_read_b32 v102, v100
    s_waitcnt lgkmcnt(0)
    v_readfirstlane_b32 s4, v102
    s_nop 2
    s_cmp_ge_u32 s4, 4
    s_cbranch_scc1 L_gs_done_73
    s_add_u32 s87, s87, 1
    s_cmp_lt_u32 s87, 400000
    s_cbranch_scc1 L_gs_72
    s_branch L_bail
L_gs_done_73:
    s_mov_b64 exec, -1
    s_cmp_lg_u32 s79, 0
    s_cbranch_scc1 L_a_noflag
    s_lshl_b32 s4, s14, 4
    v_mov_b32 v100, s4
    v_mov_b32 v101, s88
    s_mov_b64 exec, 1
    buffer_store_dword v101, v100, s[72:75], 0 offen offset:0 sc1
    s_mov_b64 exec, -1
L_a_noflag:
    s_lshl_b32 s4, s84, 5
    s_lshl_b32 s5, s86, 4
    s_add_u32 s4, s4, s5
    s_lshl_b32 s5, s79, 2
    s_add_u32 s4, s4, s5
    s_lshl_b32 s4, s4, 10
    s_add_u32 s4, s4, 131072
    v_lshlrev_b32 v232, 4, v0
    v_add_u32 v232, s4, v232
    s_lshl_b32 s5, s79, 2
    s_add_u32 s5, s5, 0
    s_and_b32 s6, s5, 7
    s_lshl_b32 s6, s6, 1
    s_lshr_b32 s7, s5, 3
    s_mul_i32 s7, s7, 9
    s_xor_b32 s6, s6, s7
    v_xor_b32 v236, s6, v0
    v_lshlrev_b32 v236, 4, v236
    s_lshl_b32 s5, s5, 10
    s_add_u32 s5, s5, 131072
    v_add_u32 v236, s5, v236
    s_lshl_b32 s5, s79, 2
    s_add_u32 s5, s5, 1
    s_and_b32 s6, s5, 7
    s_lshl_b32 s6, s6, 1
    s_lshr_b32 s7, s5, 3
    s_mul_i32 s7, s7, 9
    s_xor_b32 s6, s6, s7
    v_xor_b32 v237, s6, v0
    v_lshlrev_b32 v237, 4, v237
    s_lshl_b32 s5, s5, 10
    s_add_u32 s5, s5, 131072
    v_add_u32 v237, s5, v237
    s_lshl_b32 s5, s79, 2
    s_add_u32 s5, s5, 2
    s_and_b32 s6, s5, 7
    s_lshl_b32 s6, s6, 1
    s_lshr_b32 s7, s5, 3
    s_mul_i32 s7, s7, 9
    s_xor_b32 s6, s6, s7
    v_xor_b32 v238, s6, v0
    v_lshlrev_b32 v238, 4, v238
    s_lshl_b32 s5, s5, 10
    s_add_u32 s5, s5, 131072
    v_add_u32 v238, s5, v238
    s_lshl_b32 s5, s79, 2
    s_add_u32 s5, s5, 3
    s_and_b32 s6, s5, 7
    s_lshl_b32 s6, s6, 1
    s_lshr_b32 s7, s5, 3
    s_mul_i32 s7, s7, 9
    s_xor_b32 s6, s6, s7
    v_xor_b32 v239, s6, v0
    v_lshlrev_b32 v239, 4, v239
    s_lshl_b32 s5, s5, 10
    s_add_u32 s5, s5, 131072
    v_add_u32 v239, s5, v239
    v_and_b32 v240, 7, v1
    v_lshlrev_b32 v240, 1, v240
    v_lshrrev_b32 v241, 3, v1
    v_mul_u32_u24 v241, 9, v241
    v_xor_b32 v240, v240, v241
    v_and_b32 v241, 3, v240
    v_xor_b32 v241, v241, v2
    v_lshlrev_b32 v241, 4, v241
    v_lshl_add_u32 v241, v1, 10, v241
    v_lshrrev_b32 v240, 2, v240
    s_lshl_b32 s4, s79, 15
    v_xor_b32 v242, 0, v240
    v_lshl_add_u32 v242, v242, 6, v241
    v_add_u32 v8, 131072, v242
    v_add_u32 v12, s4, v242
    v_xor_b32 v242, 1, v240
    v_lshl_add_u32 v242, v242, 6, v241
    v_add_u32 v9, 131072, v242
    v_add_u32 v13, s4, v242
    v_xor_b32 v242, 2, v240
    v_lshl_add_u32 v242, v242, 6, v241
    v_add_u32 v10, 131072, v242
    v_add_u32 v14, s4, v242
    v_xor_b32 v242, 3, v240
    v_lshl_add_u32 v242, v242, 6, v241
    v_add_u32 v11, 131072, v242
    v_add_u32 v15, s4, v242
    v_lshlrev_b32 v243, 4, v1
    v_add_u32 v243, 158464, v243
    s_lshl_b32 s4, s79, 2
    v_add_u32 v244, s4, v243
    v_lshlrev_b32 v245, 4, v0
    s_lshl_b32 s4, s79, 10
    s_add_u32 s4, s4, 154368
    v_add_u32 v245, s4, v245
    s_sleep 40
    v_lshlrev_b32 v246, 4, v0
L_f_fl:
    buffer_load_dword v216, v246, s[72:75], 0 offen offset:0 sc1
    buffer_load_dword v217, v246, s[72:75], 0 offen offset:1024 sc1
    s_waitcnt vmcnt(0)
    v_xor_b32 v216, s88, v216
    v_xor_b32 v217, s88, v217
    v_or_b32 v216, v216, v217
    v_cmp_ne_u32 vcc, 0, v216
    s_cbranch_vccz L_f_fl_done
    s_sleep 4
    s_add_u32 s87, s87, 1
    s_cmp_lt_u32 s87, 400000
    s_cbranch_scc1 L_f_fl
    s_branch L_bail
L_f_fl_done:
    s_barrier
    ds_read_b128 v[16:19], v12 offset:0
    ds_read_b128 v[20:23], v13 offset:0
    ds_read_b128 v[24:27], v14 offset:0
    ds_read_b128 v[28:31], v15 offset:0
    ds_read_b128 v[32:35], v12 offset:256
    ds_read_b128 v[36:39], v13 offset:256
    ds_read_b128 v[40:43], v14 offset:256
    ds_read_b128 v[44:47], v15 offset:256
    ds_read_b128 v[48:51], v12 offset:512
    ds_read_b128 v[52:55], v13 offset:512
    ds_read_b128 v[56:59], v14 offset:512
    ds_read_b128 v[60:63], v15 offset:512
    ds_read_b128 v[64:67], v12 offset:768
    ds_read_b128 v[68:71], v13 offset:768
    ds_read_b128 v[72:75], v14 offset:768
    ds_read_b128 v[76:79], v15 offset:768
    ds_read_b128 v[80:83], v12 offset:16384
    ds_read_b128 v[84:87], v13 offset:16384
    ds_read_b128 v[88:91], v14 offset:16384
    ds_read_b128 v[92:95], v15 offset:16384
    ds_read_b128 v[96:99], v12 offset:16640
    ds_read_b128 v[100:103], v13 offset:16640
    ds_read_b128 v[104:107], v14 offset:16640
    ds_read_b128 v[108:111], v15 offset:16640
    ds_read_b128 v[112:115], v12 offset:16896
    ds_read_b128 v[116:119], v13 offset:16896
    ds_read_b128 v[120:123], v14 offset:16896
    ds_read_b128 v[124:127], v15 offset:16896
    ds_read_b128 v[128:131], v12 offset:17152
    ds_read_b128 v[132:135], v13 offset:17152
    ds_read_b128 v[136:139], v14 offset:17152
    ds_read_b128 v[140:143], v15 offset:17152
    s_waitcnt lgkmcnt(0)
    s_barrier
    v_mov_b32 v246, 131056
    s_mov_b64 exec, 0x1
L_lp_74:
    buffer_load_dwordx4 v[216:219], v246, s[72:75], 0 offen offset:0 sc1
    s_waitcnt vmcnt(0)
    v_and_b32 v216, v216, v218
    v_and_b32 v216, 1, v216
    v_cmp_eq_u32 vcc, 0, v216
    s_cbranch_vccz L_lp_done_75
    s_sleep 1
    s_add_u32 s87, s87, 1
    s_cmp_lt_u32 s87, 400000
    s_cbranch_scc1 L_lp_74
    s_branch L_bail
L_lp_done_75:
    s_mov_b64 exec, -1
    s_mov_b32 s96, 15
L_gp_76:
    s_bitcmp1_b32 s96, 0
    s_cbranch_scc0 L_gs__78
    buffer_load_dwordx4 v[216:219], v232, s[72:75], 0 offen offset:0 sc1
L_gs__78:
    s_bitcmp1_b32 s96, 1
    s_cbranch_scc0 L_gs__79
    buffer_load_dwordx4 v[220:223], v232, s[72:75], 0 offen offset:1024 sc1
L_gs__79:
    s_bitcmp1_b32 s96, 2
    s_cbranch_scc0 L_gs__80
    buffer_load_dwordx4 v[224:227], v232, s[72:75], 0 offen offset:2048 sc1
L_gs__80:
    s_bitcmp1_b32 s96, 3
    s_cbranch_scc0 L_gs__81
    buffer_load_dwordx4 v[228:231], v232, s[72:75], 0 offen offset:3072 sc1
L_gs__81:
    s_waitcnt vmcnt(0)
    s_bitcmp1_b32 s96, 0
    s_cbranch_scc0 L_gc__82
    v_and_b32 v246, v216, v218
    v_and_b32 v246, 1, v246
    v_cmp_eq_u32 vcc, 0, v246
    s_cbranch_vccnz L_gc__82
    s_bitset0_b32 s96, 0
L_gc__82:
    s_bitcmp1_b32 s96, 1
    s_cbranch_scc0 L_gc__83
    v_and_b32 v246, v220, v222
    v_and_b32 v246, 1, v246
    v_cmp_eq_u32 vcc, 0, v246
    s_cbranch_vccnz L_gc__83
    s_bitset0_b32 s96, 1
L_gc__83:
    s_bitcmp1_b32 s96, 2
    s_cbranch_scc0 L_gc__84
    v_and_b32 v246, v224, v226
    v_and_b32 v246, 1, v246
    v_cmp_eq_u32 vcc, 0, v246
    s_cbranch_vccnz L_gc__84
    s_bitset0_b32 s96, 2
L_gc__84:
    s_bitcmp1_b32 s96, 3
    s_cbranch_scc0 L_gc__85
    v_and_b32 v246, v228, v230
    v_and_b32 v246, 1, v246
    v_cmp_eq_u32 vcc, 0, v246
    s_cbranch_vccnz L_gc__85
    s_bitset0_b32 s96, 3
L_gc__85:
    s_cmp_eq_u32 s96, 0
    s_cbranch_scc1 L_gp_done_77
    s_add_u32 s87, s87, 1
    s_cmp_lt_u32 s87, 400000
    s_cbranch_scc1 L_gp_76
    s_branch L_bail
L_gp_done_77:
    ds_write_b128 v236, v[216:219]
    ds_write_b128 v237, v[220:223]
    ds_write_b128 v238, v[224:227]
    ds_write_b128 v239, v[228:231]
    s_waitcnt lgkmcnt(0)
    s_barrier
    ds_read_b128 v[144:147], v8 offset:0
    ds_read_b128 v[148:151], v9 offset:0
    ds_read_b128 v[152:155], v10 offset:0
    ds_read_b128 v[156:159], v11 offset:0
    ds_read_b128 v[160:163], v8 offset:256
    ds_read_b128 v[164:167], v9 offset:256
    ds_read_b128 v[168:171], v10 offset:256
    ds_read_b128 v[172:175], v11 offset:256
    ds_read_b128 v[176:179], v8 offset:512
    ds_read_b128 v[180:183], v9 offset:512
    ds_read_b128 v[184:187], v10 offset:512
    ds_read_b128 v[188:191], v11 offset:512
    ds_read_b128 v[192:195], v8 offset:768
    ds_read_b128 v[196:199], v9 offset:768
    ds_read_b128 v[200:203], v10 offset:768
    ds_read_b128 v[204:207], v11 offset:768
    s_waitcnt lgkmcnt(15)
    v_mfma_f32_16x16x32_bf16 v[208:211], v[16:19], v[144:147], 0
    v_mfma_f32_16x16x32_bf16 v[212:215], v[80:83], v[144:147], 0
    s_waitcnt lgkmcnt(14)
    v_mfma_f32_16x16x32_bf16 v[208:211], v[20:23], v[148:151], v[208:211]
    v_mfma_f32_16x16x32_bf16 v[212:215], v[84:87], v[148:151], v[212:215]
    s_waitcnt lgkmcnt(13)
    v_mfma_f32_16x16x32_bf16 v[208:211], v[24:27], v[152:155], v[208:211]
    v_mfma_f32_16x16x32_bf16 v[212:215], v[88:91], v[152:155], v[212:215]
    s_waitcnt lgkmcnt(12)
    v_mfma_f32_16x16x32_bf16 v[208:211], v[28:31], v[156:159], v[208:211]
    v_mfma_f32_16x16x32_bf16 v[212:215], v[92:95], v[156:159], v[212:215]
    s_waitcnt lgkmcnt(11)
    v_mfma_f32_16x16x32_bf16 v[208:211], v[32:35], v[160:163], v[208:211]
    v_mfma_f32_16x16x32_bf16 v[212:215], v[96:99], v[160:163], v[212:215]
    s_waitcnt lgkmcnt(10)
    v_mfma_f32_16x16x32_bf16 v[208:211], v[36:39], v[164:167], v[208:211]
    v_mfma_f32_16x16x32_bf16 v[212:215], v[100:103], v[164:167], v[212:215]
    s_waitcnt lgkmcnt(9)
    v_mfma_f32_16x16x32_bf16 v[208:211], v[40:43], v[168:171], v[208:211]
    v_mfma_f32_16x16x32_bf16 v[212:215], v[104:107], v[168:171], v[212:215]
    s_waitcnt lgkmcnt(8)
    v_mfma_f32_16x16x32_bf16 v[208:211], v[44:47], v[172:175], v[208:211]
    v_mfma_f32_16x16x32_bf16 v[212:215], v[108:111], v[172:175], v[212:215]
    s_waitcnt lgkmcnt(7)
    v_mfma_f32_16x16x32_bf16 v[208:211], v[48:51], v[176:179], v[208:211]
    v_mfma_f32_16x16x32_bf16 v[212:215], v[112:115], v[176:179], v[212:215]
    s_waitcnt lgkmcnt(6)
    v_mfma_f32_16x16x32_bf16 v[208:211], v[52:55], v[180:183], v[208:211]
    v_mfma_f32_16x16x32_bf16 v[212:215], v[116:119], v[180:183], v[212:215]
    s_waitcnt lgkmcnt(5)
    v_mfma_f32_16x16x32_bf16 v[208:211], v[56:59], v[184:187], v[208:211]
    v_mfma_f32_16x16x32_bf16 v[212:215], v[120:123], v[184:187], v[212:215]
    s_waitcnt lgkmcnt(4)
    v_mfma_f32_16x16x32_bf16 v[208:211], v[60:63], v[188:191], v[208:211]
    v_mfma_f32_16x16x32_bf16 v[212:215], v[124:127], v[188:191], v[212:215]
    s_waitcnt lgkmcnt(3)
    v_mfma_f32_16x16x32_bf16 v[208:211], v[64:67], v[192:195], v[208:211]
    v_mfma_f32_16x16x32_bf16 v[212:215], v[128:131], v[192:195], v[212:215]
    s_waitcnt lgkmcnt(2)
    v_mfma_f32_16x16x32_bf16 v[208:211], v[68:71], v[196:199], v[208:211]
    v_mfma_f32_16x16x32_bf16 v[212:215], v[132:135], v[196:199], v[212:215]
    s_waitcnt lgkmcnt(1)
    v_mfma_f32_16x16x32_bf16 v[208:211], v[72:75], v[200:203], v[208:211]
    v_mfma_f32_16x16x32_bf16 v[212:215], v[136:139], v[200:203], v[212:215]
    s_waitcnt lgkmcnt(0)
    v_mfma_f32_16x16x32_bf16 v[208:211], v[76:79], v[204:207], v[208:211]
    v_mfma_f32_16x16x32_bf16 v[212:215], v[140:143], v[204:207], v[212:215]
    s_nop 7
    s_nop 1
    v_max3_f32 v216, v208, v209, v210
    v_max3_f32 v216, v216, v211, v212
    v_max3_f32 v216, v216, v213, v214
    v_max_f32 v216, v216, v215
    v_mov_b32 v217, v216
    s_nop 1
    v_permlane16_swap_b32 v216, v217
    s_nop 1
    v_max_f32 v216, v216, v217
    v_mov_b32 v217, v216
    s_nop 1
    v_permlane32_swap_b32 v216, v217
    s_nop 1
    v_max_f32 v216, v216, v217
    s_mov_b64 exec, 0xffff
    ds_write_b32 v244, v216
    s_mov_b64 exec, -1
    s_waitcnt lgkmcnt(0)
    s_barrier
    ds_read_b128 v[220:223], v243
    s_waitcnt lgkmcnt(0)
    v_max3_f32 v216, v220, v221, v222
    v_max_f32 v216, v216, v223
    v_sub_f32 v208, v208, v216
    v_sub_f32 v209, v209, v216
    v_sub_f32 v210, v210, v216
    v_sub_f32 v211, v211, v216
    v_sub_f32 v212, v212, v216
    v_sub_f32 v213, v213, v216
    v_sub_f32 v214, v214, v216
    v_sub_f32 v215, v215, v216
    v_exp_f32 v208, v208
    v_exp_f32 v209, v209
    v_exp_f32 v210, v210
    v_exp_f32 v211, v211
    v_exp_f32 v212, v212
    v_exp_f32 v213, v213
    v_exp_f32 v214, v214
    v_exp_f32 v215, v215
    s_nop 0
    v_cvt_pk_bf16_f32 v220, v208, v209
    v_cvt_pk_bf16_f32 v221, v210, v211
    v_cvt_pk_bf16_f32 v222, v212, v213
    v_cvt_pk_bf16_f32 v223, v214, v215
    ds_write_b128 v245, v[220:223]
    v_add_f32 v218, v208, v209
    v_add_f32 v218, v218, v210
    v_add_f32 v218, v218, v211
    v_add_f32 v218, v218, v212
    v_add_f32 v218, v218, v213
    v_add_f32 v218, v218, v214
    v_add_f32 v218, v218, v215
    v_mov_b32 v217, v218
    s_nop 1
    v_permlane16_swap_b32 v218, v217
    s_nop 1
    v_add_f32 v218, v218, v217
    v_mov_b32 v217, v218
    s_nop 1
    v_permlane32_swap_b32 v218, v217
    s_nop 1
    v_add_f32 v218, v218, v217
    s_mov_b64 exec, 0xffff
    ds_write_b32 v244, v218 offset:256
    s_mov_b64 exec, -1
    s_waitcnt lgkmcnt(0)
    s_barrier
    s_branch L_a_p4pre
L_a_back:
    s_barrier
    v_mov_b32 v208, 159008
L_a_zw:
    ds_read_b32 v209, v208
    s_waitcnt lgkmcnt(0)
    v_readfirstlane_b32 s4, v209
    s_nop 2
    s_cmp_ge_u32 s4, 4
    s_cbranch_scc1 L_a_zw_done
    s_sleep 1
    s_add_u32 s87, s87, 1
    s_cmp_lt_u32 s87, 400000
    s_cbranch_scc1 L_a_zw
    s_branch L_bail
L_a_zw_done:
    s_sleep 70
    s_lshl_b32 s4, s81, 7
    s_lshl_b32 s5, s79, 5
    s_add_u32 s4, s4, s5
    s_lshl_b32 s8, s4, 10
    s_lshl_b32 s5, s79, 15
    v_lshlrev_b32 v208, 4, v0
    v_xor_b32 v209, 0, v208
    v_xor_b32 v210, 32, v208
    v_xor_b32 v211, 64, v208
    v_xor_b32 v212, 96, v208
    v_xor_b32 v213, 128, v208
    v_xor_b32 v214, 160, v208
    v_xor_b32 v215, 192, v208
    v_xor_b32 v216, 224, v208
    v_xor_b32 v217, 144, v208
    v_xor_b32 v218, 176, v208
    v_xor_b32 v219, 208, v208
    v_xor_b32 v220, 240, v208
    v_xor_b32 v221, 16, v208
    v_xor_b32 v222, 48, v208
    v_xor_b32 v223, 80, v208
    v_xor_b32 v224, 112, v208
    s_mov_b32 m0, s5
    s_nop 0
    buffer_load_dwordx4 v209, s[20:23], s8 offen offset:0 nt lds
    buffer_load_dwordx4 v210, s[20:23], s8 offen offset:1024 nt lds
    buffer_load_dwordx4 v211, s[20:23], s8 offen offset:2048 nt lds
    buffer_load_dwordx4 v212, s[20:23], s8 offen offset:3072 nt lds
    s_add_u32 s8, s8, 4096
    s_add_u32 s5, s5, 4096
    s_mov_b32 m0, s5
    s_nop 0
    buffer_load_dwordx4 v213, s[20:23], s8 offen offset:0 nt lds
    buffer_load_dwordx4 v214, s[20:23], s8 offen offset:1024 nt lds
    buffer_load_dwordx4 v215, s[20:23], s8 offen offset:2048 nt lds
    buffer_load_dwordx4 v216, s[20:23], s8 offen offset:3072 nt lds
    s_add_u32 s8, s8, 4096
    s_add_u32 s5, s5, 4096
    s_mov_b32 m0, s5
    s_nop 0
    buffer_load_dwordx4 v217, s[20:23], s8 offen offset:0 nt lds
    buffer_load_dwordx4 v218, s[20:23], s8 offen offset:1024 nt lds
    buffer_load_dwordx4 v219, s[20:23], s8 offen offset:2048 nt lds
    buffer_load_dwordx4 v220, s[20:23], s8 offen offset:3072 nt lds
    s_add_u32 s8, s8, 4096
    s_add_u32 s5, s5, 4096
    s_mov_b32 m0, s5
    s_nop 0
    buffer_load_dwordx4 v221, s[20:23], s8 offen offset:0 nt lds
    buffer_load_dwordx4 v222, s[20:23], s8 offen offset:1024 nt lds
    buffer_load_dwordx4 v223, s[20:23], s8 offen offset:2048 nt lds
    buffer_load_dwordx4 v224, s[20:23], s8 offen offset:3072 nt lds
    s_add_u32 s8, s8, 4096
    s_add_u32 s5, s5, 4096
    s_mov_b32 m0, s5
    s_nop 0
    buffer_load_dwordx4 v209, s[20:23], s8 offen offset:0 nt lds
    buffer_load_dwordx4 v210, s[20:23], s8 offen offset:1024 nt lds
    buffer_load_dwordx4 v211, s[20:23], s8 offen offset:2048 nt lds
    buffer_load_dwordx4 v212, s[20:23], s8 offen offset:3072 nt lds
    s_add_u32 s8, s8, 4096
    s_add_u32 s5, s5, 4096
    s_mov_b32 m0, s5
    s_nop 0
    buffer_load_dwordx4 v213, s[20:23], s8 offen offset:0 nt lds
    buffer_load_dwordx4 v214, s[20:23], s8 offen offset:1024 nt lds
    buffer_load_dwordx4 v215, s[20:23], s8 offen offset:2048 nt lds
    buffer_load_dwordx4 v216, s[20:23], s8 offen offset:3072 nt lds
    s_add_u32 s8, s8, 4096
    s_add_u32 s5, s5, 4096
    s_mov_b32 m0, s5
    s_nop 0
    buffer_load_dwordx4 v217, s[20:23], s8 offen offset:0 nt lds
    buffer_load_dwordx4 v218, s[20:23], s8 offen offset:1024 nt lds
    buffer_load_dwordx4 v219, s[20:23], s8 offen offset:2048 nt lds
    buffer_load_dwordx4 v220, s[20:23], s8 offen offset:3072 nt lds
    s_add_u32 s8, s8, 4096
    s_add_u32 s5, s5, 4096
    s_mov_b32 m0, s5
    s_nop 0
    buffer_load_dwordx4 v221, s[20:23], s8 offen offset:0 nt lds
    buffer_load_dwordx4 v222, s[20:23], s8 offen offset:1024 nt lds
    buffer_load_dwordx4 v223, s[20:23], s8 offen offset:2048 nt lds
    buffer_load_dwordx4 v224, s[20:23], s8 offen offset:3072 nt lds
    s_lshl_b32 s4, s94, 7
    s_lshl_b32 s5, s79, 5
    s_add_u32 s4, s4, s5
    v_add_u32 v228, s4, v2
    v_lshlrev_b32 v228, 13, v228
    v_lshl_add_u32 v228, v1, 4, v228
    s_lshl_b32 s4, s93, 8
    v_add_u32 v228, s4, v228
    buffer_load_dwordx4 v[16:19], v228, s[32:35], 0 offen offset:0 nt
    v_add_u32 v228, 32768, v228
    buffer_load_dwordx4 v[20:23], v228, s[32:35], 0 offen offset:0 nt
    v_add_u32 v228, 32768, v228
    buffer_load_dwordx4 v[24:27], v228, s[32:35], 0 offen offset:0 nt
    v_add_u32 v228, 32768, v228
    buffer_load_dwordx4 v[28:31], v228, s[32:35], 0 offen offset:0 nt
    v_add_u32 v228, 32768, v228
    buffer_load_dwordx4 v[32:35], v228, s[32:35], 0 offen offset:0 nt
    v_add_u32 v228, 32768, v228
    buffer_load_dwordx4 v[36:39], v228, s[32:35], 0 offen offset:0 nt
    v_add_u32 v228, 32768, v228
    buffer_load_dwordx4 v[40:43], v228, s[32:35], 0 offen offset:0 nt
    v_add_u32 v228, 32768, v228
    buffer_load_dwordx4 v[44:47], v228, s[32:35], 0 offen offset:0 nt
    v_bfe_u32 v232, v0, 2, 4
    v_and_b32 v233, 7, v232
    v_lshlrev_b32 v233, 1, v233
    v_lshrrev_b32 v234, 3, v232
    v_mul_u32_u24 v234, 9, v234
    v_xor_b32 v233, v233, v234
    v_bfe_u32 v234, v0, 1, 1
    v_xor_b32 v233, v233, v234
    v_lshlrev_b32 v233, 4, v233
    v_lshl_add_u32 v233, v232, 10, v233
    v_and_b32 v234, 1, v0
    v_lshl_add_u32 v233, v234, 3, v233
    s_lshl_b32 s4, s79, 8
    v_add_u32 v233, s4, v233
    s_waitcnt vmcnt(8)
    v_xor_b32 v208, 0, v233
    v_add_u32 v216, 0x10000, v208
    v_xor_b32 v209, 32, v233
    v_add_u32 v217, 0x10000, v209
    v_xor_b32 v210, 64, v233
    v_add_u32 v218, 0x10000, v210
    v_xor_b32 v211, 96, v233
    v_add_u32 v219, 0x10000, v211
    v_xor_b32 v212, 128, v233
    v_add_u32 v220, 0x10000, v212
    v_xor_b32 v213, 160, v233
    v_add_u32 v221, 0x10000, v213
    v_xor_b32 v214, 192, v233
    v_add_u32 v222, 0x10000, v214
    v_xor_b32 v215, 224, v233
    v_add_u32 v223, 0x10000, v215
    s_barrier
    s_lshl_b32 s4, s84, 5
    s_lshl_b32 s5, s86, 4
    s_add_u32 s4, s4, s5
    s_lshl_b32 s5, s79, 2
    s_add_u32 s4, s4, s5
    s_lshl_b32 s4, s4, 5
    s_add_u32 s4, s4, s85
    s_lshl_b32 s4, s4, 10
    s_add_u32 s4, s4, 401408
    v_lshlrev_b32 v228, 4, v0
    v_add_u32 v228, s4, v228
    v_mov_b32 v232, 0
    v_mov_b32 v233, 0
    v_mov_b32 v234, 0
    v_mov_b32 v235, 0
    buffer_store_dwordx4 v[232:235], v228, s[72:75], 0 offen offset:0 sc1
    v_add_u32 v228, 32768, v228
    buffer_store_dwordx4 v[232:235], v228, s[72:75], 0 offen offset:0 sc1
    v_add_u32 v228, 32768, v228
    buffer_store_dwordx4 v[232:235], v228, s[72:75], 0 offen offset:0 sc1
    v_add_u32 v228, 32768, v228
    buffer_store_dwordx4 v[232:235], v228, s[72:75], 0 offen offset:0 sc1
    ds_read_b64_tr_b16 v[80:81], v208 offset:0
    ds_read_b64_tr_b16 v[82:83], v208 offset:16384
    ds_read_b64_tr_b16 v[84:85], v208 offset:32768
    ds_read_b64_tr_b16 v[86:87], v208 offset:49152
    ds_read_b64_tr_b16 v[88:89], v216 offset:0
    ds_read_b64_tr_b16 v[90:91], v216 offset:16384
    ds_read_b64_tr_b16 v[92:93], v216 offset:32768
    ds_read_b64_tr_b16 v[94:95], v216 offset:49152
    ds_read_b64_tr_b16 v[96:97], v209 offset:0
    ds_read_b64_tr_b16 v[98:99], v209 offset:16384
    ds_read_b64_tr_b16 v[100:101], v209 offset:32768
    ds_read_b64_tr_b16 v[102:103], v209 offset:49152
    ds_read_b64_tr_b16 v[104:105], v217 offset:0
    ds_read_b64_tr_b16 v[106:107], v217 offset:16384
    ds_read_b64_tr_b16 v[108:109], v217 offset:32768
    ds_read_b64_tr_b16 v[110:111], v217 offset:49152
    ds_read_b64_tr_b16 v[112:113], v210 offset:0
    ds_read_b64_tr_b16 v[114:115], v210 offset:16384
    ds_read_b64_tr_b16 v[116:117], v210 offset:32768
    ds_read_b64_tr_b16 v[118:119], v210 offset:49152
    ds_read_b64_tr_b16 v[120:121], v218 offset:0
    ds_read_b64_tr_b16 v[122:123], v218 offset:16384
    ds_read_b64_tr_b16 v[124:125], v218 offset:32768
    ds_read_b64_tr_b16 v[126:127], v218 offset:49152
    ds_read_b64_tr_b16 v[128:129], v211 offset:0
    ds_read_b64_tr_b16 v[130:131], v211 offset:16384
    ds_read_b64_tr_b16 v[132:133], v211 offset:32768
    ds_read_b64_tr_b16 v[134:135], v211 offset:49152
    ds_read_b64_tr_b16 v[136:137], v219 offset:0
    ds_read_b64_tr_b16 v[138:139], v219 offset:16384
    ds_read_b64_tr_b16 v[140:141], v219 offset:32768
    ds_read_b64_tr_b16 v[142:143], v219 offset:49152
    ds_read_b64_tr_b16 v[144:145], v212 offset:0
    ds_read_b64_tr_b16 v[146:147], v212 offset:16384
    ds_read_b64_tr_b16 v[148:149], v212 offset:32768
    ds_read_b64_tr_b16 v[150:151], v212 offset:49152
    ds_read_b64_tr_b16 v[152:153], v220 offset:0
    ds_read_b64_tr_b16 v[154:155], v220 offset:16384
    ds_read_b64_tr_b16 v[156:157], v220 offset:32768
    ds_read_b64_tr_b16 v[158:159], v220 offset:49152
    ds_read_b64_tr_b16 v[160:161], v213 offset:0
    ds_read_b64_tr_b16 v[162:163], v213 offset:16384
    ds_read_b64_tr_b16 v[164:165], v213 offset:32768
    ds_read_b64_tr_b16 v[166:167], v213 offset:49152
    ds_read_b64_tr_b16 v[168:169], v221 offset:0
    ds_read_b64_tr_b16 v[170:171], v221 offset:16384
    ds_read_b64_tr_b16 v[172:173], v221 offset:32768
    ds_read_b64_tr_b16 v[174:175], v221 offset:49152
    ds_read_b64_tr_b16 v[176:177], v214 offset:0
    ds_read_b64_tr_b16 v[178:179], v214 offset:16384
    ds_read_b64_tr_b16 v[180:181], v214 offset:32768
    ds_read_b64_tr_b16 v[182:183], v214 offset:49152
    ds_read_b64_tr_b16 v[184:185], v222 offset:0
    ds_read_b64_tr_b16 v[186:187], v222 offset:16384
    ds_read_b64_tr_b16 v[188:189], v222 offset:32768
    ds_read_b64_tr_b16 v[190:191], v222 offset:49152
    ds_read_b64_tr_b16 v[192:193], v215 offset:0
    ds_read_b64_tr_b16 v[194:195], v215 offset:16384
    ds_read_b64_tr_b16 v[196:197], v215 offset:32768
    ds_read_b64_tr_b16 v[198:199], v215 offset:49152
    ds_read_b64_tr_b16 v[200:201], v223 offset:0
    ds_read_b64_tr_b16 v[202:203], v223 offset:16384
    ds_read_b64_tr_b16 v[204:205], v223 offset:32768
    ds_read_b64_tr_b16 v[206:207], v223 offset:49152
    s_waitcnt lgkmcnt(0)
    s_barrier
    s_waitcnt vmcnt(0)
    v_readfirstlane_b32 s88, v254
    v_readfirstlane_b32 s89, v255
    s_nop 3
    s_add_u32 s88, s88, 1
    s_addc_u32 s89, s89, 0
    s_mov_b64 exec, 1
    v_mov_b32 v232, 159016
    v_mov_b32 v233, 1
    ds_add_u32 v232, v233
    s_mov_b64 exec, -1
    s_cmp_lg_u32 s79, 0
    s_cbranch_scc1 L_a_noflag2
    v_mov_b32 v232, 159016
L_lw_86:
    ds_read_b32 v233, v232
    s_waitcnt lgkmcnt(0)
    v_readfirstlane_b32 s4, v233
    s_nop 2
    s_cmp_ge_u32 s4, 4
    s_cbranch_scc1 L_lw_done_87
    s_add_u32 s87, s87, 1
    s_cmp_lt_u32 s87, 400000
    s_cbranch_scc1 L_lw_86
    s_branch L_bail
L_lw_done_87:
    s_lshl_b32 s4, s76, 4
    s_add_u32 s4, s4, s77
    s_lshl_b32 s4, s4, 4
    s_add_u32 s4, s4, 0xB000
    v_mov_b32 v12, s4
    v_mov_b32 v13, s88
    s_mov_b64 exec, 1
    buffer_store_dword v13, v12, s[72:75], 0 offen offset:0 sc1
    s_mov_b64 exec, -1
L_a_noflag2:
    v_lshlrev_b32 v208, 4, v0
    s_lshl_b32 s4, s79, 13
    v_add_u32 v208, s4, v208
    ds_write_b128 v208, v[16:19] offset:0
    ds_write_b128 v208, v[20:23] offset:1024
    ds_write_b128 v208, v[24:27] offset:2048
    ds_write_b128 v208, v[28:31] offset:3072
    ds_write_b128 v208, v[32:35] offset:4096
    ds_write_b128 v208, v[36:39] offset:5120
    ds_write_b128 v208, v[40:43] offset:6144
    ds_write_b128 v208, v[44:47] offset:7168
    s_lshl_b32 s4, s84, 5
    s_lshl_b32 s5, s86, 4
    s_add_u32 s4, s4, s5
    v_add_u32 v12, s4, v1
    v_lshlrev_b32 v8, 5, v12
    v_add_u32 v8, s85, v8
    s_lshl_b32 s6, s84, 1
    s_add_u32 s6, s6, s86
    s_lshl_b32 s6, s6, 5
    s_add_u32 s6, s6, s85
    s_lshl_b32 s6, s6, 7
    s_add_u32 s6, s6, 196608
    v_lshlrev_b32 v9, 3, v1
    v_add_u32 v9, s6, v9
    v_lshlrev_b32 v8, 10, v8
    v_and_b32 v12, 1, v2
    v_lshrrev_b32 v13, 1, v2
    v_lshlrev_b32 v12, 5, v12
    v_lshl_add_u32 v12, v13, 4, v12
    v_add_u32 v8, v8, v12
    s_lshl_b32 s4, s79, 8
    s_add_u32 s4, s4, 401408
    v_add_u32 v8, s4, v8
    v_lshlrev_b32 v10, 4, v0
    v_add_u32 v10, 154368, v10
    v_lshlrev_b32 v11, 4, v1
    v_add_u32 v11, 158464, v11
    s_waitcnt lgkmcnt(0)
    s_barrier
    s_barrier
    s_barrier
    ds_read_b128 v[240:243], v10 offset:0
    ds_read_b128 v[244:247], v10 offset:1024
    ds_read_b128 v[248:251], v10 offset:2048
    ds_read_b128 v[252:255], v10 offset:3072
    ds_read_b128 v[48:51], v11
    ds_read_b128 v[52:55], v11 offset:256
    s_waitcnt lgkmcnt(5)
    v_mfma_f32_16x16x32_bf16 v[208:211], v[80:83], v[240:243], 0
    v_mfma_f32_16x16x32_bf16 v[212:215], v[96:99], v[240:243], 0
    v_mfma_f32_16x16x32_bf16 v[216:219], v[112:115], v[240:243], 0
    v_mfma_f32_16x16x32_bf16 v[220:223], v[128:131], v[240:243], 0
    v_mfma_f32_16x16x32_bf16 v[224:227], v[144:147], v[240:243], 0
    v_mfma_f32_16x16x32_bf16 v[228:231], v[160:163], v[240:243], 0
    v_mfma_f32_16x16x32_bf16 v[232:235], v[176:179], v[240:243], 0
    v_mfma_f32_16x16x32_bf16 v[236:239], v[192:195], v[240:243], 0
    s_waitcnt lgkmcnt(4)
    v_mfma_f32_16x16x32_bf16 v[208:211], v[84:87], v[244:247], v[208:211]
    v_mfma_f32_16x16x32_bf16 v[212:215], v[100:103], v[244:247], v[212:215]
    v_mfma_f32_16x16x32_bf16 v[216:219], v[116:119], v[244:247], v[216:219]
    v_mfma_f32_16x16x32_bf16 v[220:223], v[132:135], v[244:247], v[220:223]
    v_mfma_f32_16x16x32_bf16 v[224:227], v[148:151], v[244:247], v[224:227]
    v_mfma_f32_16x16x32_bf16 v[228:231], v[164:167], v[244:247], v[228:231]
    v_mfma_f32_16x16x32_bf16 v[232:235], v[180:183], v[244:247], v[232:235]
    v_mfma_f32_16x16x32_bf16 v[236:239], v[196:199], v[244:247], v[236:239]
    s_waitcnt lgkmcnt(3)
    v_mfma_f32_16x16x32_bf16 v[208:211], v[88:91], v[248:251], v[208:211]
    v_mfma_f32_16x16x32_bf16 v[212:215], v[104:107], v[248:251], v[212:215]
    v_mfma_f32_16x16x32_bf16 v[216:219], v[120:123], v[248:251], v[216:219]
    v_mfma_f32_16x16x32_bf16 v[220:223], v[136:139], v[248:251], v[220:223]
    v_mfma_f32_16x16x32_bf16 v[224:227], v[152:155], v[248:251], v[224:227]
    v_mfma_f32_16x16x32_bf16 v[228:231], v[168:171], v[248:251], v[228:231]
    v_mfma_f32_16x16x32_bf16 v[232:235], v[184:187], v[248:251], v[232:235]
    v_mfma_f32_16x16x32_bf16 v[236:239], v[200:203], v[248:251], v[236:239]
    s_waitcnt lgkmcnt(2)
    v_mfma_f32_16x16x32_bf16 v[208:211], v[92:95], v[252:255], v[208:211]
    v_mfma_f32_16x16x32_bf16 v[212:215], v[108:111], v[252:255], v[212:215]
    v_mfma_f32_16x16x32_bf16 v[216:219], v[124:127], v[252:255], v[216:219]
    v_mfma_f32_16x16x32_bf16 v[220:223], v[140:143], v[252:255], v[220:223]
    v_mfma_f32_16x16x32_bf16 v[224:227], v[156:159], v[252:255], v[224:227]
    v_mfma_f32_16x16x32_bf16 v[228:231], v[172:175], v[252:255], v[228:231]
    v_mfma_f32_16x16x32_bf16 v[232:235], v[188:191], v[252:255], v[232:235]
    v_mfma_f32_16x16x32_bf16 v[236:239], v[204:207], v[252:255], v[236:239]
    s_cmp_lg_u32 s79, 0
    s_cbranch_scc1 L_p3_noml
    s_waitcnt lgkmcnt(0)
    v_max3_f32 v56, v48, v49, v50
    v_max_f32 v56, v56, v51
    v_add_f32 v52, v52, v53
    v_add_f32 v54, v54, v55
    v_add_f32 v57, v52, v54
    s_mov_b64 exec, 0xffff
    buffer_store_dwordx2 v[56:57], v9, s[72:75], 0 offen offset:0 sc1
    s_mov_b64 exec, -1
L_p3_noml:
    s_nop 7
    s_nop 1
    v_cvt_pk_bf16_f32 v60, v208, v209
    v_cvt_pk_bf16_f32 v61, v210, v211
    v_cvt_pk_bf16_f32 v62, v212, v213
    v_cvt_pk_bf16_f32 v63, v214, v215
    s_nop 1
    v_permlane16_swap_b32 v60, v62
    v_permlane16_swap_b32 v61, v63
    s_nop 1
    v_or_b32 v60, 1, v60
    buffer_store_dwordx4 v[60:63], v8, s[72:75], 0 offen offset:0 sc1
    v_cvt_pk_bf16_f32 v64, v216, v217
    v_cvt_pk_bf16_f32 v65, v218, v219
    v_cvt_pk_bf16_f32 v66, v220, v221
    v_cvt_pk_bf16_f32 v67, v222, v223
    s_nop 1
    v_permlane16_swap_b32 v64, v66
    v_permlane16_swap_b32 v65, v67
    s_nop 1
    v_or_b32 v64, 1, v64
    buffer_store_dwordx4 v[64:67], v8, s[72:75], 0 offen offset:64 sc1
    v_cvt_pk_bf16_f32 v68, v224, v225
    v_cvt_pk_bf16_f32 v69, v226, v227
    v_cvt_pk_bf16_f32 v70, v228, v229
    v_cvt_pk_bf16_f32 v71, v230, v231
    s_nop 1
    v_permlane16_swap_b32 v68, v70
    v_permlane16_swap_b32 v69, v71
    s_nop 1
    v_or_b32 v68, 1, v68
    buffer_store_dwordx4 v[68:71], v8, s[72:75], 0 offen offset:128 sc1
    v_cvt_pk_bf16_f32 v72, v232, v233
    v_cvt_pk_bf16_f32 v73, v234, v235
    v_cvt_pk_bf16_f32 v74, v236, v237
    v_cvt_pk_bf16_f32 v75, v238, v239
    s_nop 1
    v_permlane16_swap_b32 v72, v74
    v_permlane16_swap_b32 v73, v75
    s_nop 1
    v_or_b32 v72, 1, v72
    buffer_store_dwordx4 v[72:75], v8, s[72:75], 0 offen offset:192 sc1
L_a_p4pre:
    v_bfe_u32 v12, v0, 2, 2
    v_lshl_add_u32 v12, v2, 3, v12
    v_lshlrev_b32 v184, 8, v12
    v_and_b32 v13, 3, v0
    v_lshl_add_u32 v184, v13, 3, v184
    s_lshl_b32 s4, s79, 6
    v_add_u32 v184, s4, v184
    ds_read_b64_tr_b16 v[16:17], v184 offset:0
    ds_read_b64_tr_b16 v[18:19], v184 offset:1024
    ds_read_b64_tr_b16 v[20:21], v184 offset:32
    ds_read_b64_tr_b16 v[22:23], v184 offset:1056
    ds_read_b64_tr_b16 v[24:25], v184 offset:8192
    ds_read_b64_tr_b16 v[26:27], v184 offset:9216
    ds_read_b64_tr_b16 v[28:29], v184 offset:8224
    ds_read_b64_tr_b16 v[30:31], v184 offset:9248
    ds_read_b64_tr_b16 v[32:33], v184 offset:16384
    ds_read_b64_tr_b16 v[34:35], v184 offset:17408
    ds_read_b64_tr_b16 v[36:37], v184 offset:16416
    ds_read_b64_tr_b16 v[38:39], v184 offset:17440
    ds_read_b64_tr_b16 v[40:41], v184 offset:24576
    ds_read_b64_tr_b16 v[42:43], v184 offset:25600
    ds_read_b64_tr_b16 v[44:45], v184 offset:24608
    ds_read_b64_tr_b16 v[46:47], v184 offset:25632
    v_lshlrev_b32 v246, 4, v0
    s_lshl_b32 s4, s90, 13
    s_add_u32 s4, s4, 65536
    v_add_u32 v246, s4, v246
    s_lshl_b32 s4, s94, 5
    s_add_u32 s4, s4, s93
    s_lshl_b32 s4, s4, 2
    s_add_u32 s4, s4, s79
    s_lshl_b32 s4, s4, 7
    s_lshl_b32 s5, s90, 6
    s_add_u32 s4, s4, s5
    s_add_u32 s4, s4, 212992
    v_lshlrev_b32 v248, 3, v2
    v_and_b32 v250, 1, v1
    v_lshl_add_u32 v248, v250, 5, v248
    v_add_u32 v248, s4, v248
    v_cmp_eq_u32 s[10:11], 1, v250
    v_lshlrev_b32 v249, 3, v1
    v_add_u32 v251, 81920, v249
    s_lshl_b32 s4, s90, 7
    v_add_u32 v249, s4, v251
    s_cmp_eq_u32 s90, 1
    s_cbranch_scc1 L_a_p4b
    s_lshl_b32 s4, s93, 5
    v_add_u32 v236, s4, v1
    v_lshlrev_b32 v236, 10, v236
    v_lshl_add_u32 v236, v2, 4, v236
    s_lshl_b32 s4, s94, 8
    s_lshl_b32 s5, s79, 6
    s_add_u32 s4, s4, s5
    s_add_u32 s4, s4, 401408
    v_add_u32 v236, s4, v236
    v_add_u32 v238, 16384, v236
    v_add_u32 v12, 0x100000, v236
    v_add_u32 v13, 0x100000, v238
    s_lshr_b32 s7, s93, 4
    s_lshl_b32 s6, s7, 12
    s_and_b32 s7, s93, 15
    s_lshl_b32 s7, s7, 3
    s_add_u32 s6, s6, s7
    s_add_u32 s6, s6, 196608
    v_lshlrev_b32 v237, 7, v1
    v_add_u32 v237, s6, v237
    v_add_u32 v14, 8192, v237
    v_lshlrev_b32 v247, 4, v0
    s_lshl_b32 s4, s79, 10
    s_add_u32 s4, s4, 65536
    v_add_u32 v247, s4, v247
    v_lshlrev_b32 v239, 4, v0
    v_add_u32 v239, 45056, v239
L_a_flb:
    buffer_load_dword v232, v239, s[72:75], 0 offen offset:0 sc1
    buffer_load_dword v233, v239, s[72:75], 0 offen offset:1024 sc1
    s_waitcnt vmcnt(0)
    v_xor_b32 v232, s88, v232
    v_xor_b32 v233, s88, v233
    v_or_b32 v232, v232, v233
    v_cmp_ne_u32 vcc, 0, v232
    s_cbranch_vccz L_a_flb_done
    s_sleep 4
    s_add_u32 s87, s87, 1
    s_cmp_lt_u32 s87, 400000
    s_cbranch_scc1 L_a_flb
    s_branch L_bail
L_a_flb_done:
    s_mov_b32 s96, 63
L_gp_88:
    s_bitcmp1_b32 s96, 0
    s_cbranch_scc0 L_gs__90
    buffer_load_dwordx2 v[232:233], v237, s[72:75], 0 offen offset:0 sc1
    buffer_load_dwordx2 v[234:235], v237, s[72:75], 0 offen offset:2048 sc1
L_gs__90:
    s_bitcmp1_b32 s96, 1
    s_cbranch_scc0 L_gs__91
    buffer_load_dwordx2 v[208:209], v14, s[72:75], 0 offen offset:0 sc1
    buffer_load_dwordx2 v[210:211], v14, s[72:75], 0 offen offset:2048 sc1
L_gs__91:
    s_bitcmp1_b32 s96, 2
    s_cbranch_scc0 L_gs__92
    buffer_load_dwordx4 v[184:187], v236, s[72:75], 0 offen offset:0 sc1
L_gs__92:
    s_bitcmp1_b32 s96, 3
    s_cbranch_scc0 L_gs__93
    buffer_load_dwordx4 v[188:191], v238, s[72:75], 0 offen offset:0 sc1
L_gs__93:
    s_bitcmp1_b32 s96, 4
    s_cbranch_scc0 L_gs__94
    buffer_load_dwordx4 v[192:195], v12, s[72:75], 0 offen offset:0 sc1
L_gs__94:
    s_bitcmp1_b32 s96, 5
    s_cbranch_scc0 L_gs__95
    buffer_load_dwordx4 v[196:199], v13, s[72:75], 0 offen offset:0 sc1
L_gs__95:
    s_waitcnt vmcnt(0)
    s_bitcmp1_b32 s96, 0
    s_cbranch_scc0 L_gc__96
    v_min_u32 v239, v233, v235
    v_cmp_eq_u32 vcc, 0, v239
    s_cbranch_vccnz L_gc__96
    s_bitset0_b32 s96, 0
L_gc__96:
    s_bitcmp1_b32 s96, 1
    s_cbranch_scc0 L_gc__97
    v_min_u32 v239, v209, v211
    v_cmp_eq_u32 vcc, 0, v239
    s_cbranch_vccnz L_gc__97
    s_bitset0_b32 s96, 1
L_gc__97:
    s_bitcmp1_b32 s96, 2
    s_cbranch_scc0 L_gc__98
    v_and_b32 v239, 1, v184
    v_cmp_eq_u32 vcc, 0, v239
    s_cbranch_vccnz L_gc__98
    s_bitset0_b32 s96, 2
L_gc__98:
    s_bitcmp1_b32 s96, 3
    s_cbranch_scc0 L_gc__99
    v_and_b32 v239, 1, v188
    v_cmp_eq_u32 vcc, 0, v239
    s_cbranch_vccnz L_gc__99
    s_bitset0_b32 s96, 3
L_gc__99:
    s_bitcmp1_b32 s96, 4
    s_cbranch_scc0 L_gc__100
    v_and_b32 v239, 1, v192
    v_cmp_eq_u32 vcc, 0, v239
    s_cbranch_vccnz L_gc__100
    s_bitset0_b32 s96, 4
L_gc__100:
    s_bitcmp1_b32 s96, 5
    s_cbranch_scc0 L_gc__101
    v_and_b32 v239, 1, v196
    v_cmp_eq_u32 vcc, 0, v239
    s_cbranch_vccnz L_gc__101
    s_bitset0_b32 s96, 5
L_gc__101:
    s_cmp_eq_u32 s96, 0
    s_cbranch_scc1 L_gp_done_89
    s_add_u32 s87, s87, 1
    s_cmp_lt_u32 s87, 400000
    s_cbranch_scc1 L_gp_88
    s_branch L_bail
L_gp_done_89:
    ds_write_b128 v247, v[184:187] offset:0
    ds_write_b128 v247, v[188:191] offset:4096
    ds_write_b128 v247, v[192:195] offset:8192
    ds_write_b128 v247, v[196:199] offset:12288
    v_max_f32 v240, v232, v234
    v_max_f32 v212, v208, v210
    s_nop 0
    v_max_f32_dpp v240, v240, v240 row_ror:8 row_mask:0xf bank_mask:0xf
    v_max_f32_dpp v212, v212, v212 row_ror:8 row_mask:0xf bank_mask:0xf
    s_nop 0
    v_max_f32_dpp v240, v240, v240 row_ror:4 row_mask:0xf bank_mask:0xf
    v_max_f32_dpp v212, v212, v212 row_ror:4 row_mask:0xf bank_mask:0xf
    s_nop 0
    v_max_f32_dpp v240, v240, v240 row_ror:2 row_mask:0xf bank_mask:0xf
    v_max_f32_dpp v212, v212, v212 row_ror:2 row_mask:0xf bank_mask:0xf
    s_nop 0
    v_max_f32_dpp v240, v240, v240 row_ror:1 row_mask:0xf bank_mask:0xf
    v_max_f32_dpp v212, v212, v212 row_ror:1 row_mask:0xf bank_mask:0xf
    v_sub_f32 v241, v232, v240
    v_sub_f32 v242, v234, v240
    v_sub_f32 v213, v208, v212
    v_sub_f32 v214, v210, v212
    v_exp_f32 v241, v241
    v_exp_f32 v242, v242
    v_exp_f32 v213, v213
    v_exp_f32 v214, v214
    s_nop 0
    v_mul_f32 v243, v241, v233
    v_mul_f32 v215, v213, v209
    v_fmac_f32 v243, v242, v235
    v_fmac_f32 v215, v214, v211
    s_nop 0
    v_add_f32_dpp v243, v243, v243 row_ror:8 row_mask:0xf bank_mask:0xf
    v_add_f32_dpp v215, v215, v215 row_ror:8 row_mask:0xf bank_mask:0xf
    s_nop 0
    v_add_f32_dpp v243, v243, v243 row_ror:4 row_mask:0xf bank_mask:0xf
    v_add_f32_dpp v215, v215, v215 row_ror:4 row_mask:0xf bank_mask:0xf
    s_nop 0
    v_add_f32_dpp v243, v243, v243 row_ror:2 row_mask:0xf bank_mask:0xf
    v_add_f32_dpp v215, v215, v215 row_ror:2 row_mask:0xf bank_mask:0xf
    s_nop 0
    v_add_f32_dpp v243, v243, v243 row_ror:1 row_mask:0xf bank_mask:0xf
    v_add_f32_dpp v215, v215, v215 row_ror:1 row_mask:0xf bank_mask:0xf
    v_rcp_f32 v243, v243
    v_rcp_f32 v215, v215
    s_nop 0
    v_mul_f32 v240, v241, v243
    v_mul_f32 v241, v242, v243
    v_mul_f32 v212, v213, v215
    v_mul_f32 v213, v214, v215
    ds_write_b64 v251, v[240:241]
    ds_write_b64 v251, v[212:213] offset:128
    s_waitcnt lgkmcnt(0)
L_a_p4b:
    s_barrier
    ds_read_b128 v[184:187], v246 offset:0
    ds_read_b128 v[188:191], v246 offset:1024
    ds_read_b128 v[192:195], v246 offset:2048
    ds_read_b128 v[196:199], v246 offset:3072
    ds_read_b128 v[200:203], v246 offset:4096
    ds_read_b128 v[204:207], v246 offset:5120
    ds_read_b128 v[208:211], v246 offset:6144
    ds_read_b128 v[212:215], v246 offset:7168
    ds_read_b64 v[240:241], v249
    s_waitcnt lgkmcnt(0)
    v_mfma_f32_16x16x32_bf16 v[216:219], v[16:19], v[184:187], 0
    v_mfma_f32_16x16x32_bf16 v[220:223], v[20:23], v[184:187], 0
    v_mfma_f32_16x16x32_bf16 v[224:227], v[16:19], v[200:203], 0
    v_mfma_f32_16x16x32_bf16 v[228:231], v[20:23], v[200:203], 0
    v_mfma_f32_16x16x32_bf16 v[216:219], v[24:27], v[188:191], v[216:219]
    v_mfma_f32_16x16x32_bf16 v[220:223], v[28:31], v[188:191], v[220:223]
    v_mfma_f32_16x16x32_bf16 v[224:227], v[24:27], v[204:207], v[224:227]
    v_mfma_f32_16x16x32_bf16 v[228:231], v[28:31], v[204:207], v[228:231]
    v_mfma_f32_16x16x32_bf16 v[216:219], v[32:35], v[192:195], v[216:219]
    v_mfma_f32_16x16x32_bf16 v[220:223], v[36:39], v[192:195], v[220:223]
    v_mfma_f32_16x16x32_bf16 v[224:227], v[32:35], v[208:211], v[224:227]
    v_mfma_f32_16x16x32_bf16 v[228:231], v[36:39], v[208:211], v[228:231]
    v_mfma_f32_16x16x32_bf16 v[216:219], v[40:43], v[196:199], v[216:219]
    v_mfma_f32_16x16x32_bf16 v[220:223], v[44:47], v[196:199], v[220:223]
    v_mfma_f32_16x16x32_bf16 v[224:227], v[40:43], v[212:215], v[224:227]
    v_mfma_f32_16x16x32_bf16 v[228:231], v[44:47], v[212:215], v[228:231]
    s_nop 7
    s_nop 1
    v_mul_f32 v216, v216, v240
    v_mul_f32 v217, v217, v240
    v_mul_f32 v218, v218, v240
    v_mul_f32 v219, v219, v240
    v_mul_f32 v220, v220, v240
    v_mul_f32 v221, v221, v240
    v_mul_f32 v222, v222, v240
    v_mul_f32 v223, v223, v240
    v_fmac_f32 v216, v224, v241
    v_fmac_f32 v217, v225, v241
    v_fmac_f32 v218, v226, v241
    v_fmac_f32 v219, v227, v241
    v_fmac_f32 v220, v228, v241
    v_fmac_f32 v221, v229, v241
    v_fmac_f32 v222, v230, v241
    v_fmac_f32 v223, v231, v241
    v_add_f32_dpp v216, v216, v216 row_ror:8 row_mask:0xf bank_mask:0xf
    v_add_f32_dpp v217, v217, v217 row_ror:8 row_mask:0xf bank_mask:0xf
    v_add_f32_dpp v218, v218, v218 row_ror:8 row_mask:0xf bank_mask:0xf
    v_add_f32_dpp v219, v219, v219 row_ror:8 row_mask:0xf bank_mask:0xf
    v_add_f32_dpp v220, v220, v220 row_ror:8 row_mask:0xf bank_mask:0xf
    v_add_f32_dpp v221, v221, v221 row_ror:8 row_mask:0xf bank_mask:0xf
    v_add_f32_dpp v222, v222, v222 row_ror:8 row_mask:0xf bank_mask:0xf
    v_add_f32_dpp v223, v223, v223 row_ror:8 row_mask:0xf bank_mask:0xf
    v_add_f32_dpp v216, v216, v216 row_ror:4 row_mask:0xf bank_mask:0xf
    v_add_f32_dpp v217, v217, v217 row_ror:4 row_mask:0xf bank_mask:0xf
    v_add_f32_dpp v218, v218, v218 row_ror:4 row_mask:0xf bank_mask:0xf
    v_add_f32_dpp v219, v219, v219 row_ror:4 row_mask:0xf bank_mask:0xf
    v_add_f32_dpp v220, v220, v220 row_ror:4 row_mask:0xf bank_mask:0xf
    v_add_f32_dpp v221, v221, v221 row_ror:4 row_mask:0xf bank_mask:0xf
    v_add_f32_dpp v222, v222, v222 row_ror:4 row_mask:0xf bank_mask:0xf
    v_add_f32_dpp v223, v223, v223 row_ror:4 row_mask:0xf bank_mask:0xf
    v_add_f32_dpp v216, v216, v216 row_ror:2 row_mask:0xf bank_mask:0xf
    v_add_f32_dpp v217, v217, v217 row_ror:2 row_mask:0xf bank_mask:0xf
    v_add_f32_dpp v218, v218, v218 row_ror:2 row_mask:0xf bank_mask:0xf
    v_add_f32_dpp v219, v219, v219 row_ror:2 row_mask:0xf bank_mask:0xf
    v_add_f32_dpp v220, v220, v220 row_ror:2 row_mask:0xf bank_mask:0xf
    v_add_f32_dpp v221, v221, v221 row_ror:2 row_mask:0xf bank_mask:0xf
    v_add_f32_dpp v222, v222, v222 row_ror:2 row_mask:0xf bank_mask:0xf
    v_add_f32_dpp v223, v223, v223 row_ror:2 row_mask:0xf bank_mask:0xf
    v_add_f32_dpp v216, v216, v216 row_ror:1 row_mask:0xf bank_mask:0xf
    v_add_f32_dpp v217, v217, v217 row_ror:1 row_mask:0xf bank_mask:0xf
    v_add_f32_dpp v218, v218, v218 row_ror:1 row_mask:0xf bank_mask:0xf
    v_add_f32_dpp v219, v219, v219 row_ror:1 row_mask:0xf bank_mask:0xf
    v_add_f32_dpp v220, v220, v220 row_ror:1 row_mask:0xf bank_mask:0xf
    v_add_f32_dpp v221, v221, v221 row_ror:1 row_mask:0xf bank_mask:0xf
    v_add_f32_dpp v222, v222, v222 row_ror:1 row_mask:0xf bank_mask:0xf
    v_add_f32_dpp v223, v223, v223 row_ror:1 row_mask:0xf bank_mask:0xf
    v_cvt_pk_bf16_f32 v184, v216, v217
    v_cvt_pk_bf16_f32 v185, v218, v219
    v_or_b32 v184, 1, v184
    v_cvt_pk_bf16_f32 v186, v220, v221
    v_cvt_pk_bf16_f32 v187, v222, v223
    v_or_b32 v186, 1, v186
    v_cndmask_b32 v184, v184, v186, s[10:11]
    v_cndmask_b32 v185, v185, v187, s[10:11]
    s_mov_b32 exec_lo, 0x30003
    s_mov_b32 exec_hi, 0x30003
    buffer_store_dwordx2 v[184:185], v248, s[72:75], 0 offen offset:0 sc1
    s_mov_b64 exec, -1
L_wave_end:
    s_endpgm
L_bail:
    s_mov_b64 exec, 1
    v_mov_b32 v1, 64
    v_mov_b32 v2, 0xdead
    buffer_store_dword v2, v1, s[68:71], 0 offen offset:0
L_end:
    s_endpgm

.section .rodata,"a"
.p2align 6
.amdhsa_kernel adaLN_cond__compressed_kv_cla__dense_activation_squared_relu__decode_kernel
  .amdhsa_next_free_vgpr 256
  .amdhsa_next_free_sgpr 102
  .amdhsa_accum_offset 256
  .amdhsa_group_segment_fixed_size 0
  .amdhsa_kernarg_size 128
  .amdhsa_user_sgpr_count 2
  .amdhsa_user_sgpr_kernarg_segment_ptr 1
  .amdhsa_system_sgpr_workgroup_id_x 1
.end_amdhsa_kernel
```
